```python
import torch

def _softmax(x, axis=-1):
    return torch.softmax(x, dim=axis)
def _gelu(x):
    return torch.nn.functional.gelu(x, approximate="tanh")
def _silu(x):
    return torch.nn.functional.silu(x)
def _sigmoid(x):
    return torch.sigmoid(x)
def _layernorm(x, axis=-1, eps=1e-5):
    m = x.mean(dim=axis, keepdim=True)
    v = x.var(dim=axis, keepdim=True, unbiased=False)
    return (x - m) / torch.sqrt(v + eps)
def _scatter_add(tgt, idx, src, axis=0):
    return tgt.clone().index_add_(axis, idx, src)
def _segment_sum(src, seg, n):
    out = torch.zeros((n,) + src.shape[1:], dtype=src.dtype)
    return out.index_add_(0, seg, src)
def _pad(x, pw):
    flat = tuple(v for pair in reversed(pw) for v in pair)
    return torch.nn.functional.pad(x, flat)

kernel_name = 'concat_heads__gqa_block_cached__gqa_block_cached__decode'

def setup_inputs():

    _w = (lambda a: (lambda t: t.to(torch.bfloat16) if t.is_floating_point() else t)(torch.as_tensor(a)))
    def _A_setup():
        B, Sq, D = 8, 1, 512
        Hq, Hkv, Sk, Dh = 32, 8, 8192, 128
        assert Hq % Hkv == 0, (Hq, Hkv)
        return {
            "x": _w((lambda *s: torch.randn(*s, dtype=torch.bfloat16) * 0.8)(B, Sq, D)),
            "k_cache": _w((lambda *s: torch.randn(*s, dtype=torch.bfloat16) * 0.8)(B, Hkv, Sk, Dh)),
            "v_cache": _w((lambda *s: torch.randn(*s, dtype=torch.bfloat16) * 0.05)(B, Hkv, Sk, Dh)),
            "wq": _w((lambda *s: torch.randn(*s, dtype=torch.bfloat16) * 0.8)(D, Hq * Dh) * (D ** -0.5)),
            "wo": _w((lambda *s: torch.randn(*s, dtype=torch.bfloat16) * 0.05)(Hq * Dh, D) * ((Hq * Dh) ** -0.5)),
        }
    _A_in = _A_setup()

    def _B_setup():
        B, Sq, D = 8, 1, 512
        Hq, Hkv, Sk, Dh = 32, 8, 8192, 128
        assert Hq % Hkv == 0, (Hq, Hkv)
        return {
            "x": _w((lambda *s: torch.randn(*s, dtype=torch.bfloat16) * 0.8)(B, Sq, D)),
            "k_cache": _w((lambda *s: torch.randn(*s, dtype=torch.bfloat16) * 0.8)(B, Hkv, Sk, Dh)),
            "v_cache": _w((lambda *s: torch.randn(*s, dtype=torch.bfloat16) * 0.05)(B, Hkv, Sk, Dh)),
            "wq": _w((lambda *s: torch.randn(*s, dtype=torch.bfloat16) * 0.8)(D, Hq * Dh) * (D ** -0.5)),
            "wo": _w((lambda *s: torch.randn(*s, dtype=torch.bfloat16) * 0.05)(Hq * Dh, D) * ((Hq * Dh) ** -0.5)),
        }
    _B_in = _B_setup()

    return {
        "A_x": _A_in["x"],
        "A_k_cache": _A_in["k_cache"],
        "A_v_cache": _A_in["v_cache"],
        "A_wq": _A_in["wq"],
        "A_wo": _A_in["wo"],
        "B_x": _B_in["x"],
        "B_k_cache": _B_in["k_cache"],
        "B_v_cache": _B_in["v_cache"],
        "B_wq": _B_in["wq"],
        "B_wo": _B_in["wo"],
    }

def reference(A_x, A_k_cache, A_v_cache, A_wq, A_wo, B_x, B_k_cache, B_v_cache, B_wq, B_wo):
    def _A_ref(x, k_cache, v_cache, wq, wo):
        B, Sq, D = x.shape
        Hq, Dh = 32, 128
        Hkv = k_cache.shape[1]
        rep = Hq // Hkv
        q = (lambda x, *d: x.permute(*d))((x @ wq).reshape(B, Sq, Hq, Dh), 0, 2, 1, 3)
        k = (lambda x, n, axis: torch.repeat_interleave(x, n, dim=axis))(k_cache, rep, axis=1)
        v = (lambda x, n, axis: torch.repeat_interleave(x, n, dim=axis))(v_cache, rep, axis=1)
        scores = torch.einsum("bhqd,bhkd->bhqk", q, k) * (Dh ** -0.5)
        p = _softmax(scores, axis=-1)
        o = torch.einsum("bhqk,bhkd->bhqd", p, v)
        return (lambda x, *d: x.permute(*d))(o, 0, 2, 1, 3).reshape(B, Sq, Hq * Dh) @ wo

    def _B_ref(x, k_cache, v_cache, wq, wo):
        B, Sq, D = x.shape
        Hq, Dh = 32, 128
        Hkv = k_cache.shape[1]
        rep = Hq // Hkv
        q = (lambda x, *d: x.permute(*d))((x @ wq).reshape(B, Sq, Hq, Dh), 0, 2, 1, 3)
        k = (lambda x, n, axis: torch.repeat_interleave(x, n, dim=axis))(k_cache, rep, axis=1)
        v = (lambda x, n, axis: torch.repeat_interleave(x, n, dim=axis))(v_cache, rep, axis=1)
        scores = torch.einsum("bhqd,bhkd->bhqk", q, k) * (Dh ** -0.5)
        p = _softmax(scores, axis=-1)
        o = torch.einsum("bhqk,bhkd->bhqd", p, v)
        return (lambda x, *d: x.permute(*d))(o, 0, 2, 1, 3).reshape(B, Sq, Hq * Dh) @ wo

    a = _A_ref(A_x, A_k_cache, A_v_cache, A_wq, A_wo)
    b = _B_ref(B_x, B_k_cache, B_v_cache, B_wq, B_wo)
    return torch.concatenate([a, b], axis=-1)
```

```asm
; @launch grid=(256,1,1) block=(512,1,1) lds=43264
.amdgcn_target "amdgcn-amd-amdhsa--gfx950"
.text
.globl concat_heads__gqa_block_cached__gqa_block_cached__decode_kernel
.p2align 8
.type concat_heads__gqa_block_cached__gqa_block_cached__decode_kernel,@function
concat_heads__gqa_block_cached__gqa_block_cached__decode_kernel:
  s_cmp_ge_u32 s2, 256
  s_cbranch_scc1 L_end
  s_load_dwordx8 s[4:11], s[0:1], 0
  s_load_dwordx8 s[72:79], s[0:1], 32
  s_load_dwordx8 s[80:87], s[0:1], 64
  s_load_dwordx2 s[12:13], s[0:1], 96
  v_and_b32 v89, 63, v0
  v_lshrrev_b32 v3, 6, v0
  v_and_b32 v83, 15, v89
  v_lshrrev_b32 v84, 4, v89
  v_readfirstlane_b32 s30, v3
  s_and_b32 s29, s2, 7
  s_lshr_b32 s28, s2, 7
  s_lshr_b32 s47, s2, 3
  s_and_b32 s47, s47, 15
  s_lshl_b32 s68, s28, 3
  s_add_u32 s68, s68, s29
  s_lshl_b32 s89, s68, 4
  s_add_u32 s89, s89, s47
  s_lshr_b32 s46, s47, 1
  s_and_b32 s43, s47, 1

  s_mov_b32 s40, 0x5040100
  s_mov_b32 s41, 0x7060302
  s_mov_b32 s42, 0x3e0293ee
  v_lshlrev_b32 v1, 8, v83
  v_lshl_add_u32 v1, v84, 4, v1
  v_lshlrev_b32 v2, 10, v84
  v_lshl_add_u32 v2, v83, 4, v2
  v_lshlrev_b32 v86, 16, v84
  v_lshl_add_u32 v86, v83, 2, v86
  v_lshlrev_b32 v87, 10, v83
  v_lshl_add_u32 v87, v84, 4, v87
  v_mov_b32 v90, 0
  s_waitcnt lgkmcnt(0)
  s_cmp_eq_u32 s28, 0
  s_cselect_b32 s4, s4, s74
  s_cselect_b32 s5, s5, s75
  s_cselect_b32 s6, s6, s76
  s_cselect_b32 s7, s7, s77
  s_cselect_b32 s8, s8, s78
  s_cselect_b32 s9, s9, s79
  s_cselect_b32 s10, s10, s80
  s_cselect_b32 s11, s11, s81
  s_cselect_b32 s72, s72, s82
  s_cselect_b32 s73, s73, s83
  s_mov_b32 s48, s10
  s_and_b32 s49, s11, 0xffff
  s_mov_b32 s50, 0x400000
  s_mov_b32 s51, 0x00020000
  s_mov_b32 s52, s4
  s_and_b32 s53, s5, 0xffff
  s_mov_b32 s54, 0x2000
  s_mov_b32 s55, 0x00020000
  s_mov_b32 s16, s6
  s_and_b32 s17, s7, 0xffff
  s_mov_b32 s18, 0x8000000
  s_mov_b32 s19, 0x00020000
  s_mov_b32 s20, s8
  s_and_b32 s21, s9, 0xffff
  s_mov_b32 s22, 0x8000000
  s_mov_b32 s23, 0x00020000
  s_mov_b32 s24, s12
  s_and_b32 s25, s13, 0xffff
  s_mov_b32 s26, 0x200000
  s_mov_b32 s27, 0x00020000
  s_mov_b32 s56, s72
  s_and_b32 s57, s73, 0xffff
  s_mov_b32 s58, 0x400000
  s_mov_b32 s59, 0x00020000
  s_mov_b32 s60, s84
  s_and_b32 s61, s85, 0xffff
  s_mov_b32 s62, 0x4000
  s_mov_b32 s63, 0x00020000
  s_mov_b32 s64, s86
  s_and_b32 s65, s87, 0xffff
  s_mov_b32 s66, 0x100
  s_mov_b32 s67, 0x00020000
  s_lshl_b32 s71, s46, 3
  s_add_u32 s71, s71, s29
  s_lshl_b32 s71, s71, 21
  s_lshl_b32 s34, s43, 20
  s_add_u32 s71, s71, s34
  s_mul_i32 s45, s2, 8
  s_and_b32 s45, s45, 127
  v_mov_b32 v92, 42000
  v_mov_b32 v93, 1
  s_or_b32 s31, s2, s30
  s_cmp_lg_u32 s31, 0
  s_cbranch_scc1 L_nozero
  v_lshlrev_b32 v88, 8, v89
  v_cmp_gt_u32 vcc, 48, v89
  s_mov_b32 s31, 0x1c0000
  s_and_saveexec_b64 s[36:37], vcc
  buffer_store_dword v90, v88, s[24:27], s31 offen sc1
  s_mov_b64 exec, s[36:37]
L_nozero:
  s_lshl_b32 s31, s30, 19
  s_lshl_b32 s32, s29, 10
  s_add_u32 s31, s31, s32
  s_lshl_b32 s32, s47, 6
  s_add_u32 s31, s31, s32
  s_lshl_b32 s33, s30, 7
  s_add_u32 s34, s31, 0x0
  buffer_load_dword v20, v86, s[48:51], s34 offen
  s_add_u32 s34, s31, 0x2000
  buffer_load_dword v21, v86, s[48:51], s34 offen
  s_add_u32 s34, s31, 0x4000
  buffer_load_dword v22, v86, s[48:51], s34 offen
  s_add_u32 s34, s31, 0x6000
  buffer_load_dword v23, v86, s[48:51], s34 offen
  s_add_u32 s34, s31, 0x8000
  buffer_load_dword v24, v86, s[48:51], s34 offen
  s_add_u32 s34, s31, 0xa000
  buffer_load_dword v25, v86, s[48:51], s34 offen
  s_add_u32 s34, s31, 0xc000
  buffer_load_dword v26, v86, s[48:51], s34 offen
  s_add_u32 s34, s31, 0xe000
  buffer_load_dword v27, v86, s[48:51], s34 offen
  s_add_u32 s34, s31, 0x40000
  buffer_load_dword v28, v86, s[48:51], s34 offen
  s_add_u32 s34, s31, 0x42000
  buffer_load_dword v29, v86, s[48:51], s34 offen
  s_add_u32 s34, s31, 0x44000
  buffer_load_dword v30, v86, s[48:51], s34 offen
  s_add_u32 s34, s31, 0x46000
  buffer_load_dword v31, v86, s[48:51], s34 offen
  s_add_u32 s34, s31, 0x48000
  buffer_load_dword v32, v86, s[48:51], s34 offen
  s_add_u32 s34, s31, 0x4a000
  buffer_load_dword v33, v86, s[48:51], s34 offen
  s_add_u32 s34, s31, 0x4c000
  buffer_load_dword v34, v86, s[48:51], s34 offen
  s_add_u32 s34, s31, 0x4e000
  buffer_load_dword v35, v86, s[48:51], s34 offen
  buffer_load_dwordx4 v[36:39], v87, s[52:55], s33 offen
  buffer_load_dwordx4 v[40:43], v87, s[52:55], s33 offen offset:64
  s_cmp_eq_u32 s30, 0
  s_cbranch_scc1 L_w0_nopf
  s_sub_u32 s35, s30, 1
  s_add_u32 s33, s35, s45
  s_and_b32 s33, s33, 127
  s_lshl_b32 s33, s33, 13
  s_add_u32 s33, s33, s71
  s_add_u32 s34, s33, 4096
  buffer_load_dwordx4 v[96:99], v1, s[16:19], s33 offen offset:0 nt
  buffer_load_dwordx4 v[100:103], v1, s[16:19], s33 offen offset:64 nt
  buffer_load_dwordx4 v[104:107], v1, s[16:19], s33 offen offset:128 nt
  buffer_load_dwordx4 v[108:111], v1, s[16:19], s33 offen offset:192 nt
  buffer_load_dwordx4 v[112:115], v1, s[16:19], s34 offen offset:0 nt
  buffer_load_dwordx4 v[116:119], v1, s[16:19], s34 offen offset:64 nt
  buffer_load_dwordx4 v[120:123], v1, s[16:19], s34 offen offset:128 nt
  buffer_load_dwordx4 v[124:127], v1, s[16:19], s34 offen offset:192 nt
  buffer_load_dwordx4 v[128:131], v2, s[20:23], s33 offen offset:0 nt
  buffer_load_dwordx4 v[132:135], v2, s[20:23], s33 offen offset:256 nt
  buffer_load_dwordx4 v[136:139], v2, s[20:23], s33 offen offset:512 nt
  buffer_load_dwordx4 v[140:143], v2, s[20:23], s33 offen offset:768 nt
  buffer_load_dwordx4 v[144:147], v2, s[20:23], s34 offen offset:0 nt
  buffer_load_dwordx4 v[148:151], v2, s[20:23], s34 offen offset:256 nt
  buffer_load_dwordx4 v[152:155], v2, s[20:23], s34 offen offset:512 nt
  buffer_load_dwordx4 v[156:159], v2, s[20:23], s34 offen offset:768 nt
  s_waitcnt vmcnt(16)
  s_branch L_w_join
L_w0_nopf:
  v_mov_b32 v85, 14
  s_mov_b64 exec, 1
  ds_write_b32 v92, v85
  ds_write_b32 v92, v90 offset:4
  s_mov_b64 exec, -1
  s_cmp_lg_u32 s2, 0
  s_cbranch_scc1 L_w0_noflag
  s_waitcnt vmcnt(18)
  s_mov_b64 exec, 1
  buffer_store_dword v93, v90, s[64:67], 0 offen sc1
  s_mov_b64 exec, -1
L_w0_noflag:
  s_waitcnt vmcnt(0)
L_w_join:
  v_perm_b32 v44, v21, v20, s40
  v_perm_b32 v45, v23, v22, s40
  v_perm_b32 v46, v25, v24, s40
  v_perm_b32 v47, v27, v26, s40
  v_perm_b32 v48, v21, v20, s41
  v_perm_b32 v49, v23, v22, s41
  v_perm_b32 v50, v25, v24, s41
  v_perm_b32 v51, v27, v26, s41
  s_nop 1
  v_mfma_f32_16x16x32_bf16 v[52:55], v[36:39], v[44:47], 0
  v_mfma_f32_16x16x32_bf16 v[56:59], v[36:39], v[48:51], 0
  v_perm_b32 v44, v29, v28, s40
  v_perm_b32 v45, v31, v30, s40
  v_perm_b32 v46, v33, v32, s40
  v_perm_b32 v47, v35, v34, s40
  v_perm_b32 v48, v29, v28, s41
  v_perm_b32 v49, v31, v30, s41
  v_perm_b32 v50, v33, v32, s41
  v_perm_b32 v51, v35, v34, s41
  s_nop 1
  v_mfma_f32_16x16x32_bf16 v[52:55], v[40:43], v[44:47], v[52:55]
  v_mfma_f32_16x16x32_bf16 v[56:59], v[40:43], v[48:51], v[56:59]
  s_nop 7
  s_nop 3
  v_lshlrev_b32 v88, 10, v3
  v_lshl_add_u32 v88, v84, 9, v88
  v_lshl_add_u32 v88, v83, 3, v88
  v_cmp_gt_u32 vcc, 32, v89
  s_and_saveexec_b64 s[36:37], vcc
  ds_write_b32 v88, v52 offset:0
  ds_write_b32 v88, v53 offset:128
  ds_write_b32 v88, v54 offset:256
  ds_write_b32 v88, v55 offset:384
  ds_write_b32 v88, v56 offset:4
  ds_write_b32 v88, v57 offset:132
  ds_write_b32 v88, v58 offset:260
  ds_write_b32 v88, v59 offset:388
  s_mov_b64 exec, s[36:37]
  s_waitcnt lgkmcnt(0)
  s_barrier
  s_cmp_lg_u32 s30, 0
  s_cbranch_scc1 L_q_others
  v_lshlrev_b32 v88, 4, v89
  ds_read_b128 v[20:23], v88 offset:0
  ds_read_b128 v[24:27], v88 offset:1024
  ds_read_b128 v[28:31], v88 offset:2048
  ds_read_b128 v[32:35], v88 offset:3072
  ds_read_b128 v[36:39], v88 offset:4096
  ds_read_b128 v[40:43], v88 offset:5120
  ds_read_b128 v[44:47], v88 offset:6144
  ds_read_b128 v[48:51], v88 offset:7168
  s_waitcnt lgkmcnt(0)
  v_add_f32 v20, v20, v24
  v_add_f32 v21, v21, v25
  v_add_f32 v22, v22, v26
  v_add_f32 v23, v23, v27
  v_add_f32 v28, v28, v32
  v_add_f32 v29, v29, v33
  v_add_f32 v30, v30, v34
  v_add_f32 v31, v31, v35
  v_add_f32 v36, v36, v40
  v_add_f32 v37, v37, v41
  v_add_f32 v38, v38, v42
  v_add_f32 v39, v39, v43
  v_add_f32 v44, v44, v48
  v_add_f32 v45, v45, v49
  v_add_f32 v46, v46, v50
  v_add_f32 v47, v47, v51
  v_add_f32 v20, v20, v28
  v_add_f32 v21, v21, v29
  v_add_f32 v22, v22, v30
  v_add_f32 v23, v23, v31
  v_add_f32 v36, v36, v44
  v_add_f32 v37, v37, v45
  v_add_f32 v38, v38, v46
  v_add_f32 v39, v39, v47
  v_add_f32 v20, v20, v36
  v_add_f32 v21, v21, v37
  v_add_f32 v22, v22, v38
  v_add_f32 v23, v23, v39
  v_cvt_pk_bf16_f32 v20, v20, v21
  v_cvt_pk_bf16_f32 v21, v22, v23
  v_lshrrev_b32 v88, 3, v89
  v_lshlrev_b32 v88, 10, v88
  v_and_b32 v87, 7, v89
  v_lshl_add_u32 v88, v87, 3, v88
  s_lshl_b32 s31, s68, 13
  s_lshl_b32 s32, s47, 6
  s_add_u32 s31, s31, s32
  buffer_store_dwordx2 v[20:21], v88, s[24:27], s31 offen sc1
  s_mov_b64 exec, 1
  s_mov_b32 s38, 400000
L_f_poll:
  buffer_load_dword v87, v90, s[64:67], 0 offen sc1
  s_waitcnt vmcnt(0)
  v_readfirstlane_b32 s39, v87
  s_cmp_lg_u32 s39, 0
  s_cbranch_scc1 L_f_done
  s_sleep 2
  s_sub_u32 s38, s38, 1
  s_cmp_lg_u32 s38, 0
  s_cbranch_scc1 L_f_poll
L_f_done:
  s_lshl_b32 s31, s68, 8
  s_add_u32 s31, s31, 0x1c2000
  buffer_atomic_add v93, v90, s[24:27], s31 offen sc1
  ds_write_b32 v92, v93 offset:4
  s_mov_b32 s38, 400000
L_q_poll:
  buffer_load_dword v87, v90, s[24:27], s31 offen sc1
  s_waitcnt vmcnt(0)
  v_readfirstlane_b32 s39, v87
  s_cmp_ge_u32 s39, 16
  s_cbranch_scc1 L_q_done
  s_sleep 2
  s_sub_u32 s38, s38, 1
  s_cmp_lg_u32 s38, 0
  s_cbranch_scc1 L_q_poll
L_q_done:
  s_mov_b64 exec, -1
  s_lshl_b32 s31, s68, 13
  s_lshl_b32 s32, s46, 10
  s_add_u32 s31, s31, s32
  v_lshlrev_b32 v88, 4, v89
  buffer_load_dwordx4 v[20:23], v88, s[24:27], s31 offen sc1

  s_waitcnt vmcnt(0)
  ds_write_b128 v88, v[20:23] offset:42240
  s_waitcnt lgkmcnt(0)
  s_branch L_q_wait
L_q_others:
  s_mov_b32 s38, 400000
L_go_poll:
  ds_read_b32 v87, v92 offset:4
  s_waitcnt lgkmcnt(0)
  v_readfirstlane_b32 s39, v87
  s_cmp_lg_u32 s39, 0
  s_cbranch_scc1 L_go_done
  s_sleep 2
  s_sub_u32 s38, s38, 1
  s_cmp_lg_u32 s38, 0
  s_cbranch_scc1 L_go_poll
L_go_done:
  s_add_u32 s35, s30, 6
  s_add_u32 s33, s35, s45
  s_and_b32 s33, s33, 127
  s_lshl_b32 s33, s33, 13
  s_add_u32 s33, s33, s71
  s_add_u32 s34, s33, 4096
  buffer_load_dwordx4 v[160:163], v1, s[16:19], s33 offen offset:0 nt
  buffer_load_dwordx4 v[164:167], v1, s[16:19], s33 offen offset:64 nt
  buffer_load_dwordx4 v[168:171], v1, s[16:19], s33 offen offset:128 nt
  buffer_load_dwordx4 v[172:175], v1, s[16:19], s33 offen offset:192 nt
  buffer_load_dwordx4 v[176:179], v1, s[16:19], s34 offen offset:0 nt
  buffer_load_dwordx4 v[180:183], v1, s[16:19], s34 offen offset:64 nt
  buffer_load_dwordx4 v[184:187], v1, s[16:19], s34 offen offset:128 nt
  buffer_load_dwordx4 v[188:191], v1, s[16:19], s34 offen offset:192 nt
  buffer_load_dwordx4 v[192:195], v2, s[20:23], s33 offen offset:0 nt
  buffer_load_dwordx4 v[196:199], v2, s[20:23], s33 offen offset:256 nt
  buffer_load_dwordx4 v[200:203], v2, s[20:23], s33 offen offset:512 nt
  buffer_load_dwordx4 v[204:207], v2, s[20:23], s33 offen offset:768 nt
  buffer_load_dwordx4 v[208:211], v2, s[20:23], s34 offen offset:0 nt
  buffer_load_dwordx4 v[212:215], v2, s[20:23], s34 offen offset:256 nt
  buffer_load_dwordx4 v[216:219], v2, s[20:23], s34 offen offset:512 nt
  buffer_load_dwordx4 v[220:223], v2, s[20:23], s34 offen offset:768 nt
L_q_wait:
  s_barrier
  v_mov_b32 v4, 0
  v_mov_b32 v5, 0
  v_mov_b32 v6, 0
  v_mov_b32 v7, 0
  v_mov_b32 v8, 0
  v_mov_b32 v9, 0
  v_mov_b32 v10, 0
  v_mov_b32 v11, 0
  v_mov_b32 v12, 0
  v_mov_b32 v13, 0
  v_mov_b32 v14, 0
  v_mov_b32 v15, 0
  v_mov_b32 v16, 0
  v_mov_b32 v17, 0
  v_mov_b32 v18, 0
  v_mov_b32 v19, 0
  v_cmp_gt_u32 vcc, 4, v83
  s_and_saveexec_b64 s[36:37], vcc
  ds_read_b128 v[4:7], v1 offset:42240
  ds_read_b128 v[8:11], v1 offset:42304
  ds_read_b128 v[12:15], v1 offset:42368
  ds_read_b128 v[16:19], v1 offset:42432
  s_mov_b64 exec, s[36:37]
  v_mov_b32 v20, 0
  v_mov_b32 v21, 0
  v_mov_b32 v22, 0
  v_mov_b32 v23, 0
  v_mov_b32 v24, 0
  v_mov_b32 v25, 0
  v_mov_b32 v26, 0
  v_mov_b32 v27, 0
  v_mov_b32 v28, 0
  v_mov_b32 v29, 0
  v_mov_b32 v30, 0
  v_mov_b32 v31, 0
  v_mov_b32 v32, 0
  v_mov_b32 v33, 0
  v_mov_b32 v34, 0
  v_mov_b32 v35, 0
  v_mov_b32 v36, 0
  v_mov_b32 v37, 0
  v_mov_b32 v38, 0
  v_mov_b32 v39, 0
  v_mov_b32 v40, 0
  v_mov_b32 v41, 0
  v_mov_b32 v42, 0
  v_mov_b32 v43, 0
  v_mov_b32 v44, 0
  v_mov_b32 v45, 0
  v_mov_b32 v46, 0
  v_mov_b32 v47, 0
  v_mov_b32 v48, 0
  v_mov_b32 v49, 0
  v_mov_b32 v50, 0
  v_mov_b32 v51, 0
  v_mov_b32 v76, 0xff800000
  v_mov_b32 v77, 0xff800000
  v_mov_b32 v78, 0
  s_waitcnt lgkmcnt(0)
  s_cmp_lg_u32 s30, 0
  s_cbranch_scc1 L_first_grab
  s_mov_b64 exec, 1
  ds_add_rtn_u32 v85, v92, v93
  s_mov_b64 exec, -1
  s_waitcnt lgkmcnt(0)
  v_readfirstlane_b32 s35, v85
  s_cmp_ge_u32 s35, 128
  s_cbranch_scc1 L_loop_done
  s_add_u32 s33, s35, s45
  s_and_b32 s33, s33, 127
  s_lshl_b32 s33, s33, 13
  s_add_u32 s33, s33, s71
  s_add_u32 s34, s33, 4096
  buffer_load_dwordx4 v[96:99], v1, s[16:19], s33 offen offset:0 nt
  buffer_load_dwordx4 v[100:103], v1, s[16:19], s33 offen offset:64 nt
  buffer_load_dwordx4 v[104:107], v1, s[16:19], s33 offen offset:128 nt
  buffer_load_dwordx4 v[108:111], v1, s[16:19], s33 offen offset:192 nt
  buffer_load_dwordx4 v[112:115], v1, s[16:19], s34 offen offset:0 nt
  buffer_load_dwordx4 v[116:119], v1, s[16:19], s34 offen offset:64 nt
  buffer_load_dwordx4 v[120:123], v1, s[16:19], s34 offen offset:128 nt
  buffer_load_dwordx4 v[124:127], v1, s[16:19], s34 offen offset:192 nt
  buffer_load_dwordx4 v[128:131], v2, s[20:23], s33 offen offset:0 nt
  buffer_load_dwordx4 v[132:135], v2, s[20:23], s33 offen offset:256 nt
  buffer_load_dwordx4 v[136:139], v2, s[20:23], s33 offen offset:512 nt
  buffer_load_dwordx4 v[140:143], v2, s[20:23], s33 offen offset:768 nt
  buffer_load_dwordx4 v[144:147], v2, s[20:23], s34 offen offset:0 nt
  buffer_load_dwordx4 v[148:151], v2, s[20:23], s34 offen offset:256 nt
  buffer_load_dwordx4 v[152:155], v2, s[20:23], s34 offen offset:512 nt
  buffer_load_dwordx4 v[156:159], v2, s[20:23], s34 offen offset:768 nt
  s_mov_b64 exec, 1
  ds_add_rtn_u32 v85, v92, v93
  s_mov_b64 exec, -1
  s_waitcnt lgkmcnt(0)
  v_readfirstlane_b32 s35, v85
  s_cmp_ge_u32 s35, 128
  s_cbranch_scc1 L_single
  s_add_u32 s33, s35, s45
  s_and_b32 s33, s33, 127
  s_lshl_b32 s33, s33, 13
  s_add_u32 s33, s33, s71
  s_add_u32 s34, s33, 4096
  buffer_load_dwordx4 v[160:163], v1, s[16:19], s33 offen offset:0 nt
  buffer_load_dwordx4 v[164:167], v1, s[16:19], s33 offen offset:64 nt
  buffer_load_dwordx4 v[168:171], v1, s[16:19], s33 offen offset:128 nt
  buffer_load_dwordx4 v[172:175], v1, s[16:19], s33 offen offset:192 nt
  buffer_load_dwordx4 v[176:179], v1, s[16:19], s34 offen offset:0 nt
  buffer_load_dwordx4 v[180:183], v1, s[16:19], s34 offen offset:64 nt
  buffer_load_dwordx4 v[184:187], v1, s[16:19], s34 offen offset:128 nt
  buffer_load_dwordx4 v[188:191], v1, s[16:19], s34 offen offset:192 nt
  buffer_load_dwordx4 v[192:195], v2, s[20:23], s33 offen offset:0 nt
  buffer_load_dwordx4 v[196:199], v2, s[20:23], s33 offen offset:256 nt
  buffer_load_dwordx4 v[200:203], v2, s[20:23], s33 offen offset:512 nt
  buffer_load_dwordx4 v[204:207], v2, s[20:23], s33 offen offset:768 nt
  buffer_load_dwordx4 v[208:211], v2, s[20:23], s34 offen offset:0 nt
  buffer_load_dwordx4 v[212:215], v2, s[20:23], s34 offen offset:256 nt
  buffer_load_dwordx4 v[216:219], v2, s[20:23], s34 offen offset:512 nt
  buffer_load_dwordx4 v[220:223], v2, s[20:23], s34 offen offset:768 nt
L_first_grab:
  s_mov_b64 exec, 1
  ds_add_rtn_u32 v85, v92, v93
  s_mov_b64 exec, -1
  s_waitcnt lgkmcnt(0)
  v_readfirstlane_b32 s35, v85
L_a_loop:
  s_cmp_ge_u32 s35, 128
  s_cbranch_scc1 L_drain_0
  s_mov_b64 exec, 1
  ds_add_rtn_u32 v85, v92, v93
  s_mov_b64 exec, -1
  s_waitcnt vmcnt(24)
  v_mfma_f32_16x16x32_bf16 v[52:55], v[96:99], v[4:7], 0
  v_mfma_f32_16x16x32_bf16 v[52:55], v[100:103], v[8:11], v[52:55]
  v_mfma_f32_16x16x32_bf16 v[52:55], v[104:107], v[12:15], v[52:55]
  v_mfma_f32_16x16x32_bf16 v[52:55], v[108:111], v[16:19], v[52:55]
  v_mfma_f32_16x16x32_bf16 v[56:59], v[112:115], v[4:7], 0
  v_mfma_f32_16x16x32_bf16 v[56:59], v[116:119], v[8:11], v[56:59]
  v_mfma_f32_16x16x32_bf16 v[56:59], v[120:123], v[12:15], v[56:59]
  v_mfma_f32_16x16x32_bf16 v[56:59], v[124:127], v[16:19], v[56:59]
  s_add_u32 s33, s35, s45
  s_and_b32 s33, s33, 127
  s_lshl_b32 s33, s33, 13
  s_add_u32 s33, s33, s71
  s_add_u32 s34, s33, 4096
  buffer_load_dwordx4 v[96:99], v1, s[16:19], s33 offen offset:0 nt
  buffer_load_dwordx4 v[100:103], v1, s[16:19], s33 offen offset:64 nt
  buffer_load_dwordx4 v[104:107], v1, s[16:19], s33 offen offset:128 nt
  buffer_load_dwordx4 v[108:111], v1, s[16:19], s33 offen offset:192 nt
  buffer_load_dwordx4 v[112:115], v1, s[16:19], s34 offen offset:0 nt
  buffer_load_dwordx4 v[116:119], v1, s[16:19], s34 offen offset:64 nt
  buffer_load_dwordx4 v[120:123], v1, s[16:19], s34 offen offset:128 nt
  buffer_load_dwordx4 v[124:127], v1, s[16:19], s34 offen offset:192 nt
  s_waitcnt lgkmcnt(0)
  v_readfirstlane_b32 s44, v85
  s_nop 1
  v_max3_f32 v81, v52, v53, v54
  v_max3_f32 v81, v81, v55, v56
  v_max3_f32 v81, v81, v57, v58
  v_max_f32 v81, v81, v59
  v_cmp_gt_f32 vcc, v81, v76
  s_cbranch_vccz L_fast_m0
  v_mov_b32 v79, v81
  s_nop 1
  v_permlane16_swap_b32 v81, v79
  v_max_f32 v81, v81, v79
  v_mov_b32 v79, v81
  s_nop 1
  v_permlane32_swap_b32 v81, v79
  v_max_f32 v81, v81, v79
  v_max_f32 v81, v81, v76
  v_sub_f32 v79, v76, v81
  v_mul_f32 v79, s42, v79
  v_exp_f32 v82, v79
  v_mov_b32 v76, v81
  v_mul_f32 v77, s42, v81
  v_mul_f32 v78, v78, v82
  v_mul_f32 v20, v20, v82
  v_mul_f32 v21, v21, v82
  v_mul_f32 v22, v22, v82
  v_mul_f32 v23, v23, v82
  v_mul_f32 v24, v24, v82
  v_mul_f32 v25, v25, v82
  v_mul_f32 v26, v26, v82
  v_mul_f32 v27, v27, v82
  v_mul_f32 v28, v28, v82
  v_mul_f32 v29, v29, v82
  v_mul_f32 v30, v30, v82
  v_mul_f32 v31, v31, v82
  v_mul_f32 v32, v32, v82
  v_mul_f32 v33, v33, v82
  v_mul_f32 v34, v34, v82
  v_mul_f32 v35, v35, v82
  v_mul_f32 v36, v36, v82
  v_mul_f32 v37, v37, v82
  v_mul_f32 v38, v38, v82
  v_mul_f32 v39, v39, v82
  v_mul_f32 v40, v40, v82
  v_mul_f32 v41, v41, v82
  v_mul_f32 v42, v42, v82
  v_mul_f32 v43, v43, v82
  v_mul_f32 v44, v44, v82
  v_mul_f32 v45, v45, v82
  v_mul_f32 v46, v46, v82
  v_mul_f32 v47, v47, v82
  v_mul_f32 v48, v48, v82
  v_mul_f32 v49, v49, v82
  v_mul_f32 v50, v50, v82
  v_mul_f32 v51, v51, v82
L_fast_m0:
  v_fma_f32 v52, v52, s42, -v77
  v_fma_f32 v53, v53, s42, -v77
  v_fma_f32 v54, v54, s42, -v77
  v_fma_f32 v55, v55, s42, -v77
  v_fma_f32 v56, v56, s42, -v77
  v_fma_f32 v57, v57, s42, -v77
  v_fma_f32 v58, v58, s42, -v77
  v_fma_f32 v59, v59, s42, -v77
  v_exp_f32 v52, v52
  v_exp_f32 v53, v53
  v_exp_f32 v54, v54
  v_exp_f32 v55, v55
  v_exp_f32 v56, v56
  v_exp_f32 v57, v57
  v_exp_f32 v58, v58
  v_exp_f32 v59, v59
  s_nop 0
  v_add_f32 v79, v52, v53
  v_add_f32 v80, v54, v55
  v_add_f32 v78, v78, v79
  v_add_f32 v78, v78, v80
  v_add_f32 v79, v56, v57
  v_add_f32 v80, v58, v59
  v_add_f32 v78, v78, v79
  v_add_f32 v78, v78, v80
  v_cvt_pk_bf16_f32 v60, v52, v53
  v_cvt_pk_bf16_f32 v61, v54, v55
  v_cvt_pk_bf16_f32 v62, v56, v57
  v_cvt_pk_bf16_f32 v63, v58, v59
  s_waitcnt vmcnt(24)
  v_perm_b32 v64, v132, v128, s40
  v_perm_b32 v65, v140, v136, s40
  v_perm_b32 v66, v148, v144, s40
  v_perm_b32 v67, v156, v152, s40
  v_perm_b32 v68, v132, v128, s41
  v_perm_b32 v69, v140, v136, s41
  v_perm_b32 v70, v148, v144, s41
  v_perm_b32 v71, v156, v152, s41
  v_mfma_f32_16x16x32_bf16 v[20:23], v[64:67], v[60:63], v[20:23]
  v_perm_b32 v72, v133, v129, s40
  v_perm_b32 v73, v141, v137, s40
  v_perm_b32 v74, v149, v145, s40
  v_perm_b32 v75, v157, v153, s40
  v_mfma_f32_16x16x32_bf16 v[24:27], v[68:71], v[60:63], v[24:27]
  v_perm_b32 v64, v133, v129, s41
  v_perm_b32 v65, v141, v137, s41
  v_perm_b32 v66, v149, v145, s41
  v_perm_b32 v67, v157, v153, s41
  v_mfma_f32_16x16x32_bf16 v[28:31], v[72:75], v[60:63], v[28:31]
  v_perm_b32 v68, v134, v130, s40
  v_perm_b32 v69, v142, v138, s40
  v_perm_b32 v70, v150, v146, s40
  v_perm_b32 v71, v158, v154, s40
  v_mfma_f32_16x16x32_bf16 v[32:35], v[64:67], v[60:63], v[32:35]
  v_perm_b32 v72, v134, v130, s41
  v_perm_b32 v73, v142, v138, s41
  v_perm_b32 v74, v150, v146, s41
  v_perm_b32 v75, v158, v154, s41
  v_mfma_f32_16x16x32_bf16 v[36:39], v[68:71], v[60:63], v[36:39]
  v_perm_b32 v64, v135, v131, s40
  v_perm_b32 v65, v143, v139, s40
  v_perm_b32 v66, v151, v147, s40
  v_perm_b32 v67, v159, v155, s40
  v_mfma_f32_16x16x32_bf16 v[40:43], v[72:75], v[60:63], v[40:43]
  v_perm_b32 v68, v135, v131, s41
  v_perm_b32 v69, v143, v139, s41
  v_perm_b32 v70, v151, v147, s41
  v_perm_b32 v71, v159, v155, s41
  v_mfma_f32_16x16x32_bf16 v[44:47], v[64:67], v[60:63], v[44:47]
  s_nop 1
  v_mfma_f32_16x16x32_bf16 v[48:51], v[68:71], v[60:63], v[48:51]
  buffer_load_dwordx4 v[128:131], v2, s[20:23], s33 offen offset:0 nt
  buffer_load_dwordx4 v[132:135], v2, s[20:23], s33 offen offset:256 nt
  buffer_load_dwordx4 v[136:139], v2, s[20:23], s33 offen offset:512 nt
  buffer_load_dwordx4 v[140:143], v2, s[20:23], s33 offen offset:768 nt
  buffer_load_dwordx4 v[144:147], v2, s[20:23], s34 offen offset:0 nt
  buffer_load_dwordx4 v[148:151], v2, s[20:23], s34 offen offset:256 nt
  buffer_load_dwordx4 v[152:155], v2, s[20:23], s34 offen offset:512 nt
  buffer_load_dwordx4 v[156:159], v2, s[20:23], s34 offen offset:768 nt
  s_mov_b32 s35, s44
  s_cmp_ge_u32 s35, 128
  s_cbranch_scc1 L_drain_1
  s_mov_b64 exec, 1
  ds_add_rtn_u32 v85, v92, v93
  s_mov_b64 exec, -1
  s_waitcnt vmcnt(24)
  v_mfma_f32_16x16x32_bf16 v[52:55], v[160:163], v[4:7], 0
  v_mfma_f32_16x16x32_bf16 v[52:55], v[164:167], v[8:11], v[52:55]
  v_mfma_f32_16x16x32_bf16 v[52:55], v[168:171], v[12:15], v[52:55]
  v_mfma_f32_16x16x32_bf16 v[52:55], v[172:175], v[16:19], v[52:55]
  v_mfma_f32_16x16x32_bf16 v[56:59], v[176:179], v[4:7], 0
  v_mfma_f32_16x16x32_bf16 v[56:59], v[180:183], v[8:11], v[56:59]
  v_mfma_f32_16x16x32_bf16 v[56:59], v[184:187], v[12:15], v[56:59]
  v_mfma_f32_16x16x32_bf16 v[56:59], v[188:191], v[16:19], v[56:59]
  s_add_u32 s33, s35, s45
  s_and_b32 s33, s33, 127
  s_lshl_b32 s33, s33, 13
  s_add_u32 s33, s33, s71
  s_add_u32 s34, s33, 4096
  buffer_load_dwordx4 v[160:163], v1, s[16:19], s33 offen offset:0 nt
  buffer_load_dwordx4 v[164:167], v1, s[16:19], s33 offen offset:64 nt
  buffer_load_dwordx4 v[168:171], v1, s[16:19], s33 offen offset:128 nt
  buffer_load_dwordx4 v[172:175], v1, s[16:19], s33 offen offset:192 nt
  buffer_load_dwordx4 v[176:179], v1, s[16:19], s34 offen offset:0 nt
  buffer_load_dwordx4 v[180:183], v1, s[16:19], s34 offen offset:64 nt
  buffer_load_dwordx4 v[184:187], v1, s[16:19], s34 offen offset:128 nt
  buffer_load_dwordx4 v[188:191], v1, s[16:19], s34 offen offset:192 nt
  s_waitcnt lgkmcnt(0)
  v_readfirstlane_b32 s44, v85
  s_nop 1
  v_max3_f32 v81, v52, v53, v54
  v_max3_f32 v81, v81, v55, v56
  v_max3_f32 v81, v81, v57, v58
  v_max_f32 v81, v81, v59
  v_cmp_gt_f32 vcc, v81, v76
  s_cbranch_vccz L_fast_m1
  v_mov_b32 v79, v81
  s_nop 1
  v_permlane16_swap_b32 v81, v79
  v_max_f32 v81, v81, v79
  v_mov_b32 v79, v81
  s_nop 1
  v_permlane32_swap_b32 v81, v79
  v_max_f32 v81, v81, v79
  v_max_f32 v81, v81, v76
  v_sub_f32 v79, v76, v81
  v_mul_f32 v79, s42, v79
  v_exp_f32 v82, v79
  v_mov_b32 v76, v81
  v_mul_f32 v77, s42, v81
  v_mul_f32 v78, v78, v82
  v_mul_f32 v20, v20, v82
  v_mul_f32 v21, v21, v82
  v_mul_f32 v22, v22, v82
  v_mul_f32 v23, v23, v82
  v_mul_f32 v24, v24, v82
  v_mul_f32 v25, v25, v82
  v_mul_f32 v26, v26, v82
  v_mul_f32 v27, v27, v82
  v_mul_f32 v28, v28, v82
  v_mul_f32 v29, v29, v82
  v_mul_f32 v30, v30, v82
  v_mul_f32 v31, v31, v82
  v_mul_f32 v32, v32, v82
  v_mul_f32 v33, v33, v82
  v_mul_f32 v34, v34, v82
  v_mul_f32 v35, v35, v82
  v_mul_f32 v36, v36, v82
  v_mul_f32 v37, v37, v82
  v_mul_f32 v38, v38, v82
  v_mul_f32 v39, v39, v82
  v_mul_f32 v40, v40, v82
  v_mul_f32 v41, v41, v82
  v_mul_f32 v42, v42, v82
  v_mul_f32 v43, v43, v82
  v_mul_f32 v44, v44, v82
  v_mul_f32 v45, v45, v82
  v_mul_f32 v46, v46, v82
  v_mul_f32 v47, v47, v82
  v_mul_f32 v48, v48, v82
  v_mul_f32 v49, v49, v82
  v_mul_f32 v50, v50, v82
  v_mul_f32 v51, v51, v82
L_fast_m1:
  v_fma_f32 v52, v52, s42, -v77
  v_fma_f32 v53, v53, s42, -v77
  v_fma_f32 v54, v54, s42, -v77
  v_fma_f32 v55, v55, s42, -v77
  v_fma_f32 v56, v56, s42, -v77
  v_fma_f32 v57, v57, s42, -v77
  v_fma_f32 v58, v58, s42, -v77
  v_fma_f32 v59, v59, s42, -v77
  v_exp_f32 v52, v52
  v_exp_f32 v53, v53
  v_exp_f32 v54, v54
  v_exp_f32 v55, v55
  v_exp_f32 v56, v56
  v_exp_f32 v57, v57
  v_exp_f32 v58, v58
  v_exp_f32 v59, v59
  s_nop 0
  v_add_f32 v79, v52, v53
  v_add_f32 v80, v54, v55
  v_add_f32 v78, v78, v79
  v_add_f32 v78, v78, v80
  v_add_f32 v79, v56, v57
  v_add_f32 v80, v58, v59
  v_add_f32 v78, v78, v79
  v_add_f32 v78, v78, v80
  v_cvt_pk_bf16_f32 v60, v52, v53
  v_cvt_pk_bf16_f32 v61, v54, v55
  v_cvt_pk_bf16_f32 v62, v56, v57
  v_cvt_pk_bf16_f32 v63, v58, v59
  s_waitcnt vmcnt(24)
  v_perm_b32 v64, v196, v192, s40
  v_perm_b32 v65, v204, v200, s40
  v_perm_b32 v66, v212, v208, s40
  v_perm_b32 v67, v220, v216, s40
  v_perm_b32 v68, v196, v192, s41
  v_perm_b32 v69, v204, v200, s41
  v_perm_b32 v70, v212, v208, s41
  v_perm_b32 v71, v220, v216, s41
  v_mfma_f32_16x16x32_bf16 v[20:23], v[64:67], v[60:63], v[20:23]
  v_perm_b32 v72, v197, v193, s40
  v_perm_b32 v73, v205, v201, s40
  v_perm_b32 v74, v213, v209, s40
  v_perm_b32 v75, v221, v217, s40
  v_mfma_f32_16x16x32_bf16 v[24:27], v[68:71], v[60:63], v[24:27]
  v_perm_b32 v64, v197, v193, s41
  v_perm_b32 v65, v205, v201, s41
  v_perm_b32 v66, v213, v209, s41
  v_perm_b32 v67, v221, v217, s41
  v_mfma_f32_16x16x32_bf16 v[28:31], v[72:75], v[60:63], v[28:31]
  v_perm_b32 v68, v198, v194, s40
  v_perm_b32 v69, v206, v202, s40
  v_perm_b32 v70, v214, v210, s40
  v_perm_b32 v71, v222, v218, s40
  v_mfma_f32_16x16x32_bf16 v[32:35], v[64:67], v[60:63], v[32:35]
  v_perm_b32 v72, v198, v194, s41
  v_perm_b32 v73, v206, v202, s41
  v_perm_b32 v74, v214, v210, s41
  v_perm_b32 v75, v222, v218, s41
  v_mfma_f32_16x16x32_bf16 v[36:39], v[68:71], v[60:63], v[36:39]
  v_perm_b32 v64, v199, v195, s40
  v_perm_b32 v65, v207, v203, s40
  v_perm_b32 v66, v215, v211, s40
  v_perm_b32 v67, v223, v219, s40
  v_mfma_f32_16x16x32_bf16 v[40:43], v[72:75], v[60:63], v[40:43]
  v_perm_b32 v68, v199, v195, s41
  v_perm_b32 v69, v207, v203, s41
  v_perm_b32 v70, v215, v211, s41
  v_perm_b32 v71, v223, v219, s41
  v_mfma_f32_16x16x32_bf16 v[44:47], v[64:67], v[60:63], v[44:47]
  s_nop 1
  v_mfma_f32_16x16x32_bf16 v[48:51], v[68:71], v[60:63], v[48:51]
  buffer_load_dwordx4 v[192:195], v2, s[20:23], s33 offen offset:0 nt
  buffer_load_dwordx4 v[196:199], v2, s[20:23], s33 offen offset:256 nt
  buffer_load_dwordx4 v[200:203], v2, s[20:23], s33 offen offset:512 nt
  buffer_load_dwordx4 v[204:207], v2, s[20:23], s33 offen offset:768 nt
  buffer_load_dwordx4 v[208:211], v2, s[20:23], s34 offen offset:0 nt
  buffer_load_dwordx4 v[212:215], v2, s[20:23], s34 offen offset:256 nt
  buffer_load_dwordx4 v[216:219], v2, s[20:23], s34 offen offset:512 nt
  buffer_load_dwordx4 v[220:223], v2, s[20:23], s34 offen offset:768 nt
  s_mov_b32 s35, s44
  s_branch L_a_loop
L_drain_0:
  s_waitcnt vmcnt(24)
  v_mfma_f32_16x16x32_bf16 v[52:55], v[96:99], v[4:7], 0
  v_mfma_f32_16x16x32_bf16 v[52:55], v[100:103], v[8:11], v[52:55]
  v_mfma_f32_16x16x32_bf16 v[52:55], v[104:107], v[12:15], v[52:55]
  v_mfma_f32_16x16x32_bf16 v[52:55], v[108:111], v[16:19], v[52:55]
  v_mfma_f32_16x16x32_bf16 v[56:59], v[112:115], v[4:7], 0
  v_mfma_f32_16x16x32_bf16 v[56:59], v[116:119], v[8:11], v[56:59]
  v_mfma_f32_16x16x32_bf16 v[56:59], v[120:123], v[12:15], v[56:59]
  v_mfma_f32_16x16x32_bf16 v[56:59], v[124:127], v[16:19], v[56:59]
  s_nop 7
  s_nop 1
  v_max3_f32 v81, v52, v53, v54
  v_max3_f32 v81, v81, v55, v56
  v_max3_f32 v81, v81, v57, v58
  v_max_f32 v81, v81, v59
  v_cmp_gt_f32 vcc, v81, v76
  s_cbranch_vccz L_fast_d0a
  v_mov_b32 v79, v81
  s_nop 1
  v_permlane16_swap_b32 v81, v79
  v_max_f32 v81, v81, v79
  v_mov_b32 v79, v81
  s_nop 1
  v_permlane32_swap_b32 v81, v79
  v_max_f32 v81, v81, v79
  v_max_f32 v81, v81, v76
  v_sub_f32 v79, v76, v81
  v_mul_f32 v79, s42, v79
  v_exp_f32 v82, v79
  v_mov_b32 v76, v81
  v_mul_f32 v77, s42, v81
  v_mul_f32 v78, v78, v82
  v_mul_f32 v20, v20, v82
  v_mul_f32 v21, v21, v82
  v_mul_f32 v22, v22, v82
  v_mul_f32 v23, v23, v82
  v_mul_f32 v24, v24, v82
  v_mul_f32 v25, v25, v82
  v_mul_f32 v26, v26, v82
  v_mul_f32 v27, v27, v82
  v_mul_f32 v28, v28, v82
  v_mul_f32 v29, v29, v82
  v_mul_f32 v30, v30, v82
  v_mul_f32 v31, v31, v82
  v_mul_f32 v32, v32, v82
  v_mul_f32 v33, v33, v82
  v_mul_f32 v34, v34, v82
  v_mul_f32 v35, v35, v82
  v_mul_f32 v36, v36, v82
  v_mul_f32 v37, v37, v82
  v_mul_f32 v38, v38, v82
  v_mul_f32 v39, v39, v82
  v_mul_f32 v40, v40, v82
  v_mul_f32 v41, v41, v82
  v_mul_f32 v42, v42, v82
  v_mul_f32 v43, v43, v82
  v_mul_f32 v44, v44, v82
  v_mul_f32 v45, v45, v82
  v_mul_f32 v46, v46, v82
  v_mul_f32 v47, v47, v82
  v_mul_f32 v48, v48, v82
  v_mul_f32 v49, v49, v82
  v_mul_f32 v50, v50, v82
  v_mul_f32 v51, v51, v82
L_fast_d0a:
  v_fma_f32 v52, v52, s42, -v77
  v_fma_f32 v53, v53, s42, -v77
  v_fma_f32 v54, v54, s42, -v77
  v_fma_f32 v55, v55, s42, -v77
  v_fma_f32 v56, v56, s42, -v77
  v_fma_f32 v57, v57, s42, -v77
  v_fma_f32 v58, v58, s42, -v77
  v_fma_f32 v59, v59, s42, -v77
  v_exp_f32 v52, v52
  v_exp_f32 v53, v53
  v_exp_f32 v54, v54
  v_exp_f32 v55, v55
  v_exp_f32 v56, v56
  v_exp_f32 v57, v57
  v_exp_f32 v58, v58
  v_exp_f32 v59, v59
  s_nop 0
  v_add_f32 v79, v52, v53
  v_add_f32 v80, v54, v55
  v_add_f32 v78, v78, v79
  v_add_f32 v78, v78, v80
  v_add_f32 v79, v56, v57
  v_add_f32 v80, v58, v59
  v_add_f32 v78, v78, v79
  v_add_f32 v78, v78, v80
  v_cvt_pk_bf16_f32 v60, v52, v53
  v_cvt_pk_bf16_f32 v61, v54, v55
  v_cvt_pk_bf16_f32 v62, v56, v57
  v_cvt_pk_bf16_f32 v63, v58, v59
  s_waitcnt vmcnt(16)
  v_perm_b32 v64, v132, v128, s40
  v_perm_b32 v65, v140, v136, s40
  v_perm_b32 v66, v148, v144, s40
  v_perm_b32 v67, v156, v152, s40
  v_perm_b32 v68, v132, v128, s41
  v_perm_b32 v69, v140, v136, s41
  v_perm_b32 v70, v148, v144, s41
  v_perm_b32 v71, v156, v152, s41
  v_mfma_f32_16x16x32_bf16 v[20:23], v[64:67], v[60:63], v[20:23]
  v_perm_b32 v72, v133, v129, s40
  v_perm_b32 v73, v141, v137, s40
  v_perm_b32 v74, v149, v145, s40
  v_perm_b32 v75, v157, v153, s40
  v_mfma_f32_16x16x32_bf16 v[24:27], v[68:71], v[60:63], v[24:27]
  v_perm_b32 v64, v133, v129, s41
  v_perm_b32 v65, v141, v137, s41
  v_perm_b32 v66, v149, v145, s41
  v_perm_b32 v67, v157, v153, s41
  v_mfma_f32_16x16x32_bf16 v[28:31], v[72:75], v[60:63], v[28:31]
  v_perm_b32 v68, v134, v130, s40
  v_perm_b32 v69, v142, v138, s40
  v_perm_b32 v70, v150, v146, s40
  v_perm_b32 v71, v158, v154, s40
  v_mfma_f32_16x16x32_bf16 v[32:35], v[64:67], v[60:63], v[32:35]
  v_perm_b32 v72, v134, v130, s41
  v_perm_b32 v73, v142, v138, s41
  v_perm_b32 v74, v150, v146, s41
  v_perm_b32 v75, v158, v154, s41
  v_mfma_f32_16x16x32_bf16 v[36:39], v[68:71], v[60:63], v[36:39]
  v_perm_b32 v64, v135, v131, s40
  v_perm_b32 v65, v143, v139, s40
  v_perm_b32 v66, v151, v147, s40
  v_perm_b32 v67, v159, v155, s40
  v_mfma_f32_16x16x32_bf16 v[40:43], v[72:75], v[60:63], v[40:43]
  v_perm_b32 v68, v135, v131, s41
  v_perm_b32 v69, v143, v139, s41
  v_perm_b32 v70, v151, v147, s41
  v_perm_b32 v71, v159, v155, s41
  v_mfma_f32_16x16x32_bf16 v[44:47], v[64:67], v[60:63], v[44:47]
  s_nop 1
  v_mfma_f32_16x16x32_bf16 v[48:51], v[68:71], v[60:63], v[48:51]
  s_waitcnt vmcnt(8)
  v_mfma_f32_16x16x32_bf16 v[52:55], v[160:163], v[4:7], 0
  v_mfma_f32_16x16x32_bf16 v[52:55], v[164:167], v[8:11], v[52:55]
  v_mfma_f32_16x16x32_bf16 v[52:55], v[168:171], v[12:15], v[52:55]
  v_mfma_f32_16x16x32_bf16 v[52:55], v[172:175], v[16:19], v[52:55]
  v_mfma_f32_16x16x32_bf16 v[56:59], v[176:179], v[4:7], 0
  v_mfma_f32_16x16x32_bf16 v[56:59], v[180:183], v[8:11], v[56:59]
  v_mfma_f32_16x16x32_bf16 v[56:59], v[184:187], v[12:15], v[56:59]
  v_mfma_f32_16x16x32_bf16 v[56:59], v[188:191], v[16:19], v[56:59]
  s_nop 7
  s_nop 1
  v_max3_f32 v81, v52, v53, v54
  v_max3_f32 v81, v81, v55, v56
  v_max3_f32 v81, v81, v57, v58
  v_max_f32 v81, v81, v59
  v_cmp_gt_f32 vcc, v81, v76
  s_cbranch_vccz L_fast_d0b
  v_mov_b32 v79, v81
  s_nop 1
  v_permlane16_swap_b32 v81, v79
  v_max_f32 v81, v81, v79
  v_mov_b32 v79, v81
  s_nop 1
  v_permlane32_swap_b32 v81, v79
  v_max_f32 v81, v81, v79
  v_max_f32 v81, v81, v76
  v_sub_f32 v79, v76, v81
  v_mul_f32 v79, s42, v79
  v_exp_f32 v82, v79
  v_mov_b32 v76, v81
  v_mul_f32 v77, s42, v81
  v_mul_f32 v78, v78, v82
  v_mul_f32 v20, v20, v82
  v_mul_f32 v21, v21, v82
  v_mul_f32 v22, v22, v82
  v_mul_f32 v23, v23, v82
  v_mul_f32 v24, v24, v82
  v_mul_f32 v25, v25, v82
  v_mul_f32 v26, v26, v82
  v_mul_f32 v27, v27, v82
  v_mul_f32 v28, v28, v82
  v_mul_f32 v29, v29, v82
  v_mul_f32 v30, v30, v82
  v_mul_f32 v31, v31, v82
  v_mul_f32 v32, v32, v82
  v_mul_f32 v33, v33, v82
  v_mul_f32 v34, v34, v82
  v_mul_f32 v35, v35, v82
  v_mul_f32 v36, v36, v82
  v_mul_f32 v37, v37, v82
  v_mul_f32 v38, v38, v82
  v_mul_f32 v39, v39, v82
  v_mul_f32 v40, v40, v82
  v_mul_f32 v41, v41, v82
  v_mul_f32 v42, v42, v82
  v_mul_f32 v43, v43, v82
  v_mul_f32 v44, v44, v82
  v_mul_f32 v45, v45, v82
  v_mul_f32 v46, v46, v82
  v_mul_f32 v47, v47, v82
  v_mul_f32 v48, v48, v82
  v_mul_f32 v49, v49, v82
  v_mul_f32 v50, v50, v82
  v_mul_f32 v51, v51, v82
L_fast_d0b:
  v_fma_f32 v52, v52, s42, -v77
  v_fma_f32 v53, v53, s42, -v77
  v_fma_f32 v54, v54, s42, -v77
  v_fma_f32 v55, v55, s42, -v77
  v_fma_f32 v56, v56, s42, -v77
  v_fma_f32 v57, v57, s42, -v77
  v_fma_f32 v58, v58, s42, -v77
  v_fma_f32 v59, v59, s42, -v77
  v_exp_f32 v52, v52
  v_exp_f32 v53, v53
  v_exp_f32 v54, v54
  v_exp_f32 v55, v55
  v_exp_f32 v56, v56
  v_exp_f32 v57, v57
  v_exp_f32 v58, v58
  v_exp_f32 v59, v59
  s_nop 0
  v_add_f32 v79, v52, v53
  v_add_f32 v80, v54, v55
  v_add_f32 v78, v78, v79
  v_add_f32 v78, v78, v80
  v_add_f32 v79, v56, v57
  v_add_f32 v80, v58, v59
  v_add_f32 v78, v78, v79
  v_add_f32 v78, v78, v80
  v_cvt_pk_bf16_f32 v60, v52, v53
  v_cvt_pk_bf16_f32 v61, v54, v55
  v_cvt_pk_bf16_f32 v62, v56, v57
  v_cvt_pk_bf16_f32 v63, v58, v59
  s_waitcnt vmcnt(0)
  v_perm_b32 v64, v196, v192, s40
  v_perm_b32 v65, v204, v200, s40
  v_perm_b32 v66, v212, v208, s40
  v_perm_b32 v67, v220, v216, s40
  v_perm_b32 v68, v196, v192, s41
  v_perm_b32 v69, v204, v200, s41
  v_perm_b32 v70, v212, v208, s41
  v_perm_b32 v71, v220, v216, s41
  v_mfma_f32_16x16x32_bf16 v[20:23], v[64:67], v[60:63], v[20:23]
  v_perm_b32 v72, v197, v193, s40
  v_perm_b32 v73, v205, v201, s40
  v_perm_b32 v74, v213, v209, s40
  v_perm_b32 v75, v221, v217, s40
  v_mfma_f32_16x16x32_bf16 v[24:27], v[68:71], v[60:63], v[24:27]
  v_perm_b32 v64, v197, v193, s41
  v_perm_b32 v65, v205, v201, s41
  v_perm_b32 v66, v213, v209, s41
  v_perm_b32 v67, v221, v217, s41
  v_mfma_f32_16x16x32_bf16 v[28:31], v[72:75], v[60:63], v[28:31]
  v_perm_b32 v68, v198, v194, s40
  v_perm_b32 v69, v206, v202, s40
  v_perm_b32 v70, v214, v210, s40
  v_perm_b32 v71, v222, v218, s40
  v_mfma_f32_16x16x32_bf16 v[32:35], v[64:67], v[60:63], v[32:35]
  v_perm_b32 v72, v198, v194, s41
  v_perm_b32 v73, v206, v202, s41
  v_perm_b32 v74, v214, v210, s41
  v_perm_b32 v75, v222, v218, s41
  v_mfma_f32_16x16x32_bf16 v[36:39], v[68:71], v[60:63], v[36:39]
  v_perm_b32 v64, v199, v195, s40
  v_perm_b32 v65, v207, v203, s40
  v_perm_b32 v66, v215, v211, s40
  v_perm_b32 v67, v223, v219, s40
  v_mfma_f32_16x16x32_bf16 v[40:43], v[72:75], v[60:63], v[40:43]
  v_perm_b32 v68, v199, v195, s41
  v_perm_b32 v69, v207, v203, s41
  v_perm_b32 v70, v215, v211, s41
  v_perm_b32 v71, v223, v219, s41
  v_mfma_f32_16x16x32_bf16 v[44:47], v[64:67], v[60:63], v[44:47]
  s_nop 1
  v_mfma_f32_16x16x32_bf16 v[48:51], v[68:71], v[60:63], v[48:51]
  s_branch L_loop_done
L_drain_1:
  s_waitcnt vmcnt(24)
  v_mfma_f32_16x16x32_bf16 v[52:55], v[160:163], v[4:7], 0
  v_mfma_f32_16x16x32_bf16 v[52:55], v[164:167], v[8:11], v[52:55]
  v_mfma_f32_16x16x32_bf16 v[52:55], v[168:171], v[12:15], v[52:55]
  v_mfma_f32_16x16x32_bf16 v[52:55], v[172:175], v[16:19], v[52:55]
  v_mfma_f32_16x16x32_bf16 v[56:59], v[176:179], v[4:7], 0
  v_mfma_f32_16x16x32_bf16 v[56:59], v[180:183], v[8:11], v[56:59]
  v_mfma_f32_16x16x32_bf16 v[56:59], v[184:187], v[12:15], v[56:59]
  v_mfma_f32_16x16x32_bf16 v[56:59], v[188:191], v[16:19], v[56:59]
  s_nop 7
  s_nop 1
  v_max3_f32 v81, v52, v53, v54
  v_max3_f32 v81, v81, v55, v56
  v_max3_f32 v81, v81, v57, v58
  v_max_f32 v81, v81, v59
  v_cmp_gt_f32 vcc, v81, v76
  s_cbranch_vccz L_fast_d1a
  v_mov_b32 v79, v81
  s_nop 1
  v_permlane16_swap_b32 v81, v79
  v_max_f32 v81, v81, v79
  v_mov_b32 v79, v81
  s_nop 1
  v_permlane32_swap_b32 v81, v79
  v_max_f32 v81, v81, v79
  v_max_f32 v81, v81, v76
  v_sub_f32 v79, v76, v81
  v_mul_f32 v79, s42, v79
  v_exp_f32 v82, v79
  v_mov_b32 v76, v81
  v_mul_f32 v77, s42, v81
  v_mul_f32 v78, v78, v82
  v_mul_f32 v20, v20, v82
  v_mul_f32 v21, v21, v82
  v_mul_f32 v22, v22, v82
  v_mul_f32 v23, v23, v82
  v_mul_f32 v24, v24, v82
  v_mul_f32 v25, v25, v82
  v_mul_f32 v26, v26, v82
  v_mul_f32 v27, v27, v82
  v_mul_f32 v28, v28, v82
  v_mul_f32 v29, v29, v82
  v_mul_f32 v30, v30, v82
  v_mul_f32 v31, v31, v82
  v_mul_f32 v32, v32, v82
  v_mul_f32 v33, v33, v82
  v_mul_f32 v34, v34, v82
  v_mul_f32 v35, v35, v82
  v_mul_f32 v36, v36, v82
  v_mul_f32 v37, v37, v82
  v_mul_f32 v38, v38, v82
  v_mul_f32 v39, v39, v82
  v_mul_f32 v40, v40, v82
  v_mul_f32 v41, v41, v82
  v_mul_f32 v42, v42, v82
  v_mul_f32 v43, v43, v82
  v_mul_f32 v44, v44, v82
  v_mul_f32 v45, v45, v82
  v_mul_f32 v46, v46, v82
  v_mul_f32 v47, v47, v82
  v_mul_f32 v48, v48, v82
  v_mul_f32 v49, v49, v82
  v_mul_f32 v50, v50, v82
  v_mul_f32 v51, v51, v82
L_fast_d1a:
  v_fma_f32 v52, v52, s42, -v77
  v_fma_f32 v53, v53, s42, -v77
  v_fma_f32 v54, v54, s42, -v77
  v_fma_f32 v55, v55, s42, -v77
  v_fma_f32 v56, v56, s42, -v77
  v_fma_f32 v57, v57, s42, -v77
  v_fma_f32 v58, v58, s42, -v77
  v_fma_f32 v59, v59, s42, -v77
  v_exp_f32 v52, v52
  v_exp_f32 v53, v53
  v_exp_f32 v54, v54
  v_exp_f32 v55, v55
  v_exp_f32 v56, v56
  v_exp_f32 v57, v57
  v_exp_f32 v58, v58
  v_exp_f32 v59, v59
  s_nop 0
  v_add_f32 v79, v52, v53
  v_add_f32 v80, v54, v55
  v_add_f32 v78, v78, v79
  v_add_f32 v78, v78, v80
  v_add_f32 v79, v56, v57
  v_add_f32 v80, v58, v59
  v_add_f32 v78, v78, v79
  v_add_f32 v78, v78, v80
  v_cvt_pk_bf16_f32 v60, v52, v53
  v_cvt_pk_bf16_f32 v61, v54, v55
  v_cvt_pk_bf16_f32 v62, v56, v57
  v_cvt_pk_bf16_f32 v63, v58, v59
  s_waitcnt vmcnt(16)
  v_perm_b32 v64, v196, v192, s40
  v_perm_b32 v65, v204, v200, s40
  v_perm_b32 v66, v212, v208, s40
  v_perm_b32 v67, v220, v216, s40
  v_perm_b32 v68, v196, v192, s41
  v_perm_b32 v69, v204, v200, s41
  v_perm_b32 v70, v212, v208, s41
  v_perm_b32 v71, v220, v216, s41
  v_mfma_f32_16x16x32_bf16 v[20:23], v[64:67], v[60:63], v[20:23]
  v_perm_b32 v72, v197, v193, s40
  v_perm_b32 v73, v205, v201, s40
  v_perm_b32 v74, v213, v209, s40
  v_perm_b32 v75, v221, v217, s40
  v_mfma_f32_16x16x32_bf16 v[24:27], v[68:71], v[60:63], v[24:27]
  v_perm_b32 v64, v197, v193, s41
  v_perm_b32 v65, v205, v201, s41
  v_perm_b32 v66, v213, v209, s41
  v_perm_b32 v67, v221, v217, s41
  v_mfma_f32_16x16x32_bf16 v[28:31], v[72:75], v[60:63], v[28:31]
  v_perm_b32 v68, v198, v194, s40
  v_perm_b32 v69, v206, v202, s40
  v_perm_b32 v70, v214, v210, s40
  v_perm_b32 v71, v222, v218, s40
  v_mfma_f32_16x16x32_bf16 v[32:35], v[64:67], v[60:63], v[32:35]
  v_perm_b32 v72, v198, v194, s41
  v_perm_b32 v73, v206, v202, s41
  v_perm_b32 v74, v214, v210, s41
  v_perm_b32 v75, v222, v218, s41
  v_mfma_f32_16x16x32_bf16 v[36:39], v[68:71], v[60:63], v[36:39]
  v_perm_b32 v64, v199, v195, s40
  v_perm_b32 v65, v207, v203, s40
  v_perm_b32 v66, v215, v211, s40
  v_perm_b32 v67, v223, v219, s40
  v_mfma_f32_16x16x32_bf16 v[40:43], v[72:75], v[60:63], v[40:43]
  v_perm_b32 v68, v199, v195, s41
  v_perm_b32 v69, v207, v203, s41
  v_perm_b32 v70, v215, v211, s41
  v_perm_b32 v71, v223, v219, s41
  v_mfma_f32_16x16x32_bf16 v[44:47], v[64:67], v[60:63], v[44:47]
  s_nop 1
  v_mfma_f32_16x16x32_bf16 v[48:51], v[68:71], v[60:63], v[48:51]
  s_waitcnt vmcnt(8)
  v_mfma_f32_16x16x32_bf16 v[52:55], v[96:99], v[4:7], 0
  v_mfma_f32_16x16x32_bf16 v[52:55], v[100:103], v[8:11], v[52:55]
  v_mfma_f32_16x16x32_bf16 v[52:55], v[104:107], v[12:15], v[52:55]
  v_mfma_f32_16x16x32_bf16 v[52:55], v[108:111], v[16:19], v[52:55]
  v_mfma_f32_16x16x32_bf16 v[56:59], v[112:115], v[4:7], 0
  v_mfma_f32_16x16x32_bf16 v[56:59], v[116:119], v[8:11], v[56:59]
  v_mfma_f32_16x16x32_bf16 v[56:59], v[120:123], v[12:15], v[56:59]
  v_mfma_f32_16x16x32_bf16 v[56:59], v[124:127], v[16:19], v[56:59]
  s_nop 7
  s_nop 1
  v_max3_f32 v81, v52, v53, v54
  v_max3_f32 v81, v81, v55, v56
  v_max3_f32 v81, v81, v57, v58
  v_max_f32 v81, v81, v59
  v_cmp_gt_f32 vcc, v81, v76
  s_cbranch_vccz L_fast_d1b
  v_mov_b32 v79, v81
  s_nop 1
  v_permlane16_swap_b32 v81, v79
  v_max_f32 v81, v81, v79
  v_mov_b32 v79, v81
  s_nop 1
  v_permlane32_swap_b32 v81, v79
  v_max_f32 v81, v81, v79
  v_max_f32 v81, v81, v76
  v_sub_f32 v79, v76, v81
  v_mul_f32 v79, s42, v79
  v_exp_f32 v82, v79
  v_mov_b32 v76, v81
  v_mul_f32 v77, s42, v81
  v_mul_f32 v78, v78, v82
  v_mul_f32 v20, v20, v82
  v_mul_f32 v21, v21, v82
  v_mul_f32 v22, v22, v82
  v_mul_f32 v23, v23, v82
  v_mul_f32 v24, v24, v82
  v_mul_f32 v25, v25, v82
  v_mul_f32 v26, v26, v82
  v_mul_f32 v27, v27, v82
  v_mul_f32 v28, v28, v82
  v_mul_f32 v29, v29, v82
  v_mul_f32 v30, v30, v82
  v_mul_f32 v31, v31, v82
  v_mul_f32 v32, v32, v82
  v_mul_f32 v33, v33, v82
  v_mul_f32 v34, v34, v82
  v_mul_f32 v35, v35, v82
  v_mul_f32 v36, v36, v82
  v_mul_f32 v37, v37, v82
  v_mul_f32 v38, v38, v82
  v_mul_f32 v39, v39, v82
  v_mul_f32 v40, v40, v82
  v_mul_f32 v41, v41, v82
  v_mul_f32 v42, v42, v82
  v_mul_f32 v43, v43, v82
  v_mul_f32 v44, v44, v82
  v_mul_f32 v45, v45, v82
  v_mul_f32 v46, v46, v82
  v_mul_f32 v47, v47, v82
  v_mul_f32 v48, v48, v82
  v_mul_f32 v49, v49, v82
  v_mul_f32 v50, v50, v82
  v_mul_f32 v51, v51, v82
L_fast_d1b:
  v_fma_f32 v52, v52, s42, -v77
  v_fma_f32 v53, v53, s42, -v77
  v_fma_f32 v54, v54, s42, -v77
  v_fma_f32 v55, v55, s42, -v77
  v_fma_f32 v56, v56, s42, -v77
  v_fma_f32 v57, v57, s42, -v77
  v_fma_f32 v58, v58, s42, -v77
  v_fma_f32 v59, v59, s42, -v77
  v_exp_f32 v52, v52
  v_exp_f32 v53, v53
  v_exp_f32 v54, v54
  v_exp_f32 v55, v55
  v_exp_f32 v56, v56
  v_exp_f32 v57, v57
  v_exp_f32 v58, v58
  v_exp_f32 v59, v59
  s_nop 0
  v_add_f32 v79, v52, v53
  v_add_f32 v80, v54, v55
  v_add_f32 v78, v78, v79
  v_add_f32 v78, v78, v80
  v_add_f32 v79, v56, v57
  v_add_f32 v80, v58, v59
  v_add_f32 v78, v78, v79
  v_add_f32 v78, v78, v80
  v_cvt_pk_bf16_f32 v60, v52, v53
  v_cvt_pk_bf16_f32 v61, v54, v55
  v_cvt_pk_bf16_f32 v62, v56, v57
  v_cvt_pk_bf16_f32 v63, v58, v59
  s_waitcnt vmcnt(0)
  v_perm_b32 v64, v132, v128, s40
  v_perm_b32 v65, v140, v136, s40
  v_perm_b32 v66, v148, v144, s40
  v_perm_b32 v67, v156, v152, s40
  v_perm_b32 v68, v132, v128, s41
  v_perm_b32 v69, v140, v136, s41
  v_perm_b32 v70, v148, v144, s41
  v_perm_b32 v71, v156, v152, s41
  v_mfma_f32_16x16x32_bf16 v[20:23], v[64:67], v[60:63], v[20:23]
  v_perm_b32 v72, v133, v129, s40
  v_perm_b32 v73, v141, v137, s40
  v_perm_b32 v74, v149, v145, s40
  v_perm_b32 v75, v157, v153, s40
  v_mfma_f32_16x16x32_bf16 v[24:27], v[68:71], v[60:63], v[24:27]
  v_perm_b32 v64, v133, v129, s41
  v_perm_b32 v65, v141, v137, s41
  v_perm_b32 v66, v149, v145, s41
  v_perm_b32 v67, v157, v153, s41
  v_mfma_f32_16x16x32_bf16 v[28:31], v[72:75], v[60:63], v[28:31]
  v_perm_b32 v68, v134, v130, s40
  v_perm_b32 v69, v142, v138, s40
  v_perm_b32 v70, v150, v146, s40
  v_perm_b32 v71, v158, v154, s40
  v_mfma_f32_16x16x32_bf16 v[32:35], v[64:67], v[60:63], v[32:35]
  v_perm_b32 v72, v134, v130, s41
  v_perm_b32 v73, v142, v138, s41
  v_perm_b32 v74, v150, v146, s41
  v_perm_b32 v75, v158, v154, s41
  v_mfma_f32_16x16x32_bf16 v[36:39], v[68:71], v[60:63], v[36:39]
  v_perm_b32 v64, v135, v131, s40
  v_perm_b32 v65, v143, v139, s40
  v_perm_b32 v66, v151, v147, s40
  v_perm_b32 v67, v159, v155, s40
  v_mfma_f32_16x16x32_bf16 v[40:43], v[72:75], v[60:63], v[40:43]
  v_perm_b32 v68, v135, v131, s41
  v_perm_b32 v69, v143, v139, s41
  v_perm_b32 v70, v151, v147, s41
  v_perm_b32 v71, v159, v155, s41
  v_mfma_f32_16x16x32_bf16 v[44:47], v[64:67], v[60:63], v[44:47]
  s_nop 1
  v_mfma_f32_16x16x32_bf16 v[48:51], v[68:71], v[60:63], v[48:51]
  s_branch L_loop_done
L_single:
  s_waitcnt vmcnt(8)
  v_mfma_f32_16x16x32_bf16 v[52:55], v[96:99], v[4:7], 0
  v_mfma_f32_16x16x32_bf16 v[52:55], v[100:103], v[8:11], v[52:55]
  v_mfma_f32_16x16x32_bf16 v[52:55], v[104:107], v[12:15], v[52:55]
  v_mfma_f32_16x16x32_bf16 v[52:55], v[108:111], v[16:19], v[52:55]
  v_mfma_f32_16x16x32_bf16 v[56:59], v[112:115], v[4:7], 0
  v_mfma_f32_16x16x32_bf16 v[56:59], v[116:119], v[8:11], v[56:59]
  v_mfma_f32_16x16x32_bf16 v[56:59], v[120:123], v[12:15], v[56:59]
  v_mfma_f32_16x16x32_bf16 v[56:59], v[124:127], v[16:19], v[56:59]
  s_nop 7
  s_nop 1
  v_max3_f32 v81, v52, v53, v54
  v_max3_f32 v81, v81, v55, v56
  v_max3_f32 v81, v81, v57, v58
  v_max_f32 v81, v81, v59
  v_cmp_gt_f32 vcc, v81, v76
  s_cbranch_vccz L_fast_sg
  v_mov_b32 v79, v81
  s_nop 1
  v_permlane16_swap_b32 v81, v79
  v_max_f32 v81, v81, v79
  v_mov_b32 v79, v81
  s_nop 1
  v_permlane32_swap_b32 v81, v79
  v_max_f32 v81, v81, v79
  v_max_f32 v81, v81, v76
  v_sub_f32 v79, v76, v81
  v_mul_f32 v79, s42, v79
  v_exp_f32 v82, v79
  v_mov_b32 v76, v81
  v_mul_f32 v77, s42, v81
  v_mul_f32 v78, v78, v82
  v_mul_f32 v20, v20, v82
  v_mul_f32 v21, v21, v82
  v_mul_f32 v22, v22, v82
  v_mul_f32 v23, v23, v82
  v_mul_f32 v24, v24, v82
  v_mul_f32 v25, v25, v82
  v_mul_f32 v26, v26, v82
  v_mul_f32 v27, v27, v82
  v_mul_f32 v28, v28, v82
  v_mul_f32 v29, v29, v82
  v_mul_f32 v30, v30, v82
  v_mul_f32 v31, v31, v82
  v_mul_f32 v32, v32, v82
  v_mul_f32 v33, v33, v82
  v_mul_f32 v34, v34, v82
  v_mul_f32 v35, v35, v82
  v_mul_f32 v36, v36, v82
  v_mul_f32 v37, v37, v82
  v_mul_f32 v38, v38, v82
  v_mul_f32 v39, v39, v82
  v_mul_f32 v40, v40, v82
  v_mul_f32 v41, v41, v82
  v_mul_f32 v42, v42, v82
  v_mul_f32 v43, v43, v82
  v_mul_f32 v44, v44, v82
  v_mul_f32 v45, v45, v82
  v_mul_f32 v46, v46, v82
  v_mul_f32 v47, v47, v82
  v_mul_f32 v48, v48, v82
  v_mul_f32 v49, v49, v82
  v_mul_f32 v50, v50, v82
  v_mul_f32 v51, v51, v82
L_fast_sg:
  v_fma_f32 v52, v52, s42, -v77
  v_fma_f32 v53, v53, s42, -v77
  v_fma_f32 v54, v54, s42, -v77
  v_fma_f32 v55, v55, s42, -v77
  v_fma_f32 v56, v56, s42, -v77
  v_fma_f32 v57, v57, s42, -v77
  v_fma_f32 v58, v58, s42, -v77
  v_fma_f32 v59, v59, s42, -v77
  v_exp_f32 v52, v52
  v_exp_f32 v53, v53
  v_exp_f32 v54, v54
  v_exp_f32 v55, v55
  v_exp_f32 v56, v56
  v_exp_f32 v57, v57
  v_exp_f32 v58, v58
  v_exp_f32 v59, v59
  s_nop 0
  v_add_f32 v79, v52, v53
  v_add_f32 v80, v54, v55
  v_add_f32 v78, v78, v79
  v_add_f32 v78, v78, v80
  v_add_f32 v79, v56, v57
  v_add_f32 v80, v58, v59
  v_add_f32 v78, v78, v79
  v_add_f32 v78, v78, v80
  v_cvt_pk_bf16_f32 v60, v52, v53
  v_cvt_pk_bf16_f32 v61, v54, v55
  v_cvt_pk_bf16_f32 v62, v56, v57
  v_cvt_pk_bf16_f32 v63, v58, v59
  s_waitcnt vmcnt(0)
  v_perm_b32 v64, v132, v128, s40
  v_perm_b32 v65, v140, v136, s40
  v_perm_b32 v66, v148, v144, s40
  v_perm_b32 v67, v156, v152, s40
  v_perm_b32 v68, v132, v128, s41
  v_perm_b32 v69, v140, v136, s41
  v_perm_b32 v70, v148, v144, s41
  v_perm_b32 v71, v156, v152, s41
  v_mfma_f32_16x16x32_bf16 v[20:23], v[64:67], v[60:63], v[20:23]
  v_perm_b32 v72, v133, v129, s40
  v_perm_b32 v73, v141, v137, s40
  v_perm_b32 v74, v149, v145, s40
  v_perm_b32 v75, v157, v153, s40
  v_mfma_f32_16x16x32_bf16 v[24:27], v[68:71], v[60:63], v[24:27]
  v_perm_b32 v64, v133, v129, s41
  v_perm_b32 v65, v141, v137, s41
  v_perm_b32 v66, v149, v145, s41
  v_perm_b32 v67, v157, v153, s41
  v_mfma_f32_16x16x32_bf16 v[28:31], v[72:75], v[60:63], v[28:31]
  v_perm_b32 v68, v134, v130, s40
  v_perm_b32 v69, v142, v138, s40
  v_perm_b32 v70, v150, v146, s40
  v_perm_b32 v71, v158, v154, s40
  v_mfma_f32_16x16x32_bf16 v[32:35], v[64:67], v[60:63], v[32:35]
  v_perm_b32 v72, v134, v130, s41
  v_perm_b32 v73, v142, v138, s41
  v_perm_b32 v74, v150, v146, s41
  v_perm_b32 v75, v158, v154, s41
  v_mfma_f32_16x16x32_bf16 v[36:39], v[68:71], v[60:63], v[36:39]
  v_perm_b32 v64, v135, v131, s40
  v_perm_b32 v65, v143, v139, s40
  v_perm_b32 v66, v151, v147, s40
  v_perm_b32 v67, v159, v155, s40
  v_mfma_f32_16x16x32_bf16 v[40:43], v[72:75], v[60:63], v[40:43]
  v_perm_b32 v68, v135, v131, s41
  v_perm_b32 v69, v143, v139, s41
  v_perm_b32 v70, v151, v147, s41
  v_perm_b32 v71, v159, v155, s41
  v_mfma_f32_16x16x32_bf16 v[44:47], v[64:67], v[60:63], v[44:47]
  s_nop 1
  v_mfma_f32_16x16x32_bf16 v[48:51], v[68:71], v[60:63], v[48:51]
L_loop_done:
  v_lshlrev_b32 v86, 13, v84
  v_lshl_add_u32 v86, v83, 3, v86
  s_lshr_b32 s69, s47, 3
  s_and_b32 s70, s47, 7
  s_lshl_b32 s31, s29, 19
  s_lshl_b32 s32, s69, 18
  s_add_u32 s31, s31, s32
  s_lshl_b32 s32, s30, 15
  s_add_u32 s31, s31, s32
  s_lshl_b32 s32, s70, 7
  s_add_u32 s31, s31, s32
  s_add_u32 s32, s31, 4096
  buffer_load_dwordx2 v[96:97], v86, s[56:59], s31 offen offset:0
  buffer_load_dwordx2 v[98:99], v86, s[56:59], s31 offen offset:1024
  buffer_load_dwordx2 v[100:101], v86, s[56:59], s31 offen offset:2048
  buffer_load_dwordx2 v[102:103], v86, s[56:59], s31 offen offset:3072
  buffer_load_dwordx2 v[104:105], v86, s[56:59], s32 offen offset:0
  buffer_load_dwordx2 v[106:107], v86, s[56:59], s32 offen offset:1024
  buffer_load_dwordx2 v[108:109], v86, s[56:59], s32 offen offset:2048
  buffer_load_dwordx2 v[110:111], v86, s[56:59], s32 offen offset:3072
  s_nop 3
  v_lshlrev_b32 v86, 11, v3
  v_lshl_add_u32 v86, v83, 9, v86
  v_lshl_add_u32 v86, v84, 7, v86
  v_lshlrev_b32 v87, 6, v3
  v_lshl_add_u32 v87, v83, 4, v87
  v_lshl_add_u32 v87, v84, 2, v87
  v_lshlrev_b32 v88, 4, v3
  v_lshl_add_u32 v88, v83, 2, v88
  v_cmp_gt_u32 vcc, 4, v83
  s_and_saveexec_b64 s[36:37], vcc
  ds_write_b32 v86, v20 offset:0
  ds_write_b32 v86, v21 offset:32
  ds_write_b32 v86, v22 offset:64
  ds_write_b32 v86, v23 offset:96
  ds_write_b32 v86, v24 offset:4
  ds_write_b32 v86, v25 offset:36
  ds_write_b32 v86, v26 offset:68
  ds_write_b32 v86, v27 offset:100
  ds_write_b32 v86, v28 offset:8
  ds_write_b32 v86, v29 offset:40
  ds_write_b32 v86, v30 offset:72
  ds_write_b32 v86, v31 offset:104
  ds_write_b32 v86, v32 offset:12
  ds_write_b32 v86, v33 offset:44
  ds_write_b32 v86, v34 offset:76
  ds_write_b32 v86, v35 offset:108
  ds_write_b32 v86, v36 offset:16
  ds_write_b32 v86, v37 offset:48
  ds_write_b32 v86, v38 offset:80
  ds_write_b32 v86, v39 offset:112
  ds_write_b32 v86, v40 offset:20
  ds_write_b32 v86, v41 offset:52
  ds_write_b32 v86, v42 offset:84
  ds_write_b32 v86, v43 offset:116
  ds_write_b32 v86, v44 offset:24
  ds_write_b32 v86, v45 offset:56
  ds_write_b32 v86, v46 offset:88
  ds_write_b32 v86, v47 offset:120
  ds_write_b32 v86, v48 offset:28
  ds_write_b32 v86, v49 offset:60
  ds_write_b32 v86, v50 offset:92
  ds_write_b32 v86, v51 offset:124
  ds_write_b32 v87, v78 offset:16384
  ds_write_b32 v88, v76 offset:16896
  s_mov_b64 exec, s[36:37]
  s_waitcnt lgkmcnt(0)
  s_barrier
  v_lshrrev_b32 v4, 7, v0
  v_lshlrev_b32 v5, 2, v4
  v_lshlrev_b32 v6, 4, v4
  v_lshlrev_b32 v7, 2, v0
  ds_read_b32 v20, v5 offset:16896
  ds_read_b32 v21, v5 offset:16912
  ds_read_b32 v22, v5 offset:16928
  ds_read_b32 v23, v5 offset:16944
  ds_read_b32 v24, v5 offset:16960
  ds_read_b32 v25, v5 offset:16976
  ds_read_b32 v26, v5 offset:16992
  ds_read_b32 v27, v5 offset:17008
  ds_read_b128 v[32:35], v6 offset:16384
  ds_read_b128 v[36:39], v6 offset:16448
  ds_read_b128 v[40:43], v6 offset:16512
  ds_read_b128 v[44:47], v6 offset:16576
  ds_read_b128 v[48:51], v6 offset:16640
  ds_read_b128 v[52:55], v6 offset:16704
  ds_read_b128 v[56:59], v6 offset:16768
  ds_read_b128 v[60:63], v6 offset:16832
  ds_read_b32 v64, v7 offset:0
  ds_read_b32 v65, v7 offset:2048
  ds_read_b32 v66, v7 offset:4096
  ds_read_b32 v67, v7 offset:6144
  ds_read_b32 v68, v7 offset:8192
  ds_read_b32 v69, v7 offset:10240
  ds_read_b32 v70, v7 offset:12288
  ds_read_b32 v71, v7 offset:14336
  s_waitcnt lgkmcnt(0)
  v_max3_f32 v8, v20, v21, v22
  v_max3_f32 v8, v8, v23, v24
  v_max3_f32 v8, v8, v25, v26
  v_max_f32 v8, v8, v27
  v_sub_f32 v20, v20, v8
  v_sub_f32 v21, v21, v8
  v_sub_f32 v22, v22, v8
  v_sub_f32 v23, v23, v8
  v_sub_f32 v24, v24, v8
  v_sub_f32 v25, v25, v8
  v_sub_f32 v26, v26, v8
  v_sub_f32 v27, v27, v8
  v_mul_f32 v20, s42, v20
  v_mul_f32 v21, s42, v21
  v_mul_f32 v22, s42, v22
  v_mul_f32 v23, s42, v23
  v_mul_f32 v24, s42, v24
  v_mul_f32 v25, s42, v25
  v_mul_f32 v26, s42, v26
  v_mul_f32 v27, s42, v27
  v_exp_f32 v20, v20
  v_exp_f32 v21, v21
  v_exp_f32 v22, v22
  v_exp_f32 v23, v23
  v_exp_f32 v24, v24
  v_exp_f32 v25, v25
  v_exp_f32 v26, v26
  v_exp_f32 v27, v27
  s_nop 0
  v_mov_b32 v9, 0
  v_mov_b32 v10, 0
  v_add_f32 v32, v32, v33
  v_add_f32 v34, v34, v35
  v_add_f32 v32, v32, v34
  v_fmac_f32 v9, v20, v32
  v_fmac_f32 v10, v20, v64
  v_add_f32 v36, v36, v37
  v_add_f32 v38, v38, v39
  v_add_f32 v36, v36, v38
  v_fmac_f32 v9, v21, v36
  v_fmac_f32 v10, v21, v65
  v_add_f32 v40, v40, v41
  v_add_f32 v42, v42, v43
  v_add_f32 v40, v40, v42
  v_fmac_f32 v9, v22, v40
  v_fmac_f32 v10, v22, v66
  v_add_f32 v44, v44, v45
  v_add_f32 v46, v46, v47
  v_add_f32 v44, v44, v46
  v_fmac_f32 v9, v23, v44
  v_fmac_f32 v10, v23, v67
  v_add_f32 v48, v48, v49
  v_add_f32 v50, v50, v51
  v_add_f32 v48, v48, v50
  v_fmac_f32 v9, v24, v48
  v_fmac_f32 v10, v24, v68
  v_add_f32 v52, v52, v53
  v_add_f32 v54, v54, v55
  v_add_f32 v52, v52, v54
  v_fmac_f32 v9, v25, v52
  v_fmac_f32 v10, v25, v69
  v_add_f32 v56, v56, v57
  v_add_f32 v58, v58, v59
  v_add_f32 v56, v56, v58
  v_fmac_f32 v9, v26, v56
  v_fmac_f32 v10, v26, v70
  v_add_f32 v60, v60, v61
  v_add_f32 v62, v62, v63
  v_add_f32 v60, v60, v62
  v_fmac_f32 v9, v27, v60
  v_fmac_f32 v10, v27, v71
  s_lshl_b32 s31, s89, 11
  s_add_u32 s31, s31, 0x40000
  buffer_store_dword v10, v7, s[24:27], s31 offen sc1
  v_and_b32 v11, 127, v0
  v_cmp_eq_u32 vcc, 0, v11
  v_lshlrev_b32 v12, 3, v4
  s_lshl_b32 s31, s89, 5
  s_add_u32 s31, s31, 0xc0000
  s_and_saveexec_b64 s[36:37], vcc
  buffer_store_dwordx2 v[8:9], v12, s[24:27], s31 offen sc1
  s_mov_b64 exec, s[36:37]

  s_waitcnt vmcnt(0)
  s_barrier
  s_cmp_lg_u32 s30, 0
  s_cbranch_scc1 L_p_wait
  s_lshl_b32 s31, s68, 8
  s_add_u32 s31, s31, 0x1c1000
  v_mov_b32 v87, 1
  s_mov_b64 s[36:37], exec
  s_mov_b64 exec, 1
  buffer_atomic_add v87, v90, s[24:27], s31 offen sc1
  s_mov_b32 s38, 400000
L_p_poll:
  buffer_load_dword v87, v90, s[24:27], s31 offen sc1
  s_waitcnt vmcnt(0)
  v_readfirstlane_b32 s39, v87
  s_cmp_ge_u32 s39, 16
  s_cbranch_scc1 L_p_done
  s_sleep 4
  s_sub_u32 s38, s38, 1
  s_cmp_lg_u32 s38, 0
  s_cbranch_scc1 L_p_poll
L_p_done:
  s_mov_b64 exec, s[36:37]
L_p_wait:
  s_barrier
  v_lshrrev_b32 v7, 5, v89
  v_and_b32 v8, 31, v89
  v_lshlrev_b32 v9, 9, v7
  v_lshl_add_u32 v9, v8, 4, v9
  v_lshlrev_b32 v10, 3, v7
  s_lshl_b32 s33, s68, 4
  s_lshl_b32 s34, s30, 1
  s_add_u32 s33, s33, s34
  s_lshl_b32 s36, s33, 11
  s_lshl_b32 s37, s69, 10
  s_add_u32 s36, s36, s37
  s_add_u32 s36, s36, 0x40000
  s_lshl_b32 s38, s33, 5
  s_lshl_b32 s37, s69, 4
  s_add_u32 s38, s38, s37
  s_add_u32 s38, s38, 0xc0000
  buffer_load_dwordx4 v[32:35], v9, s[24:27], s36 offen sc1
  buffer_load_dwordx4 v[36:39], v9, s[24:27], s36 offen offset:2048 sc1
  buffer_load_dwordx2 v[40:41], v10, s[24:27], s38 offen sc1
  buffer_load_dwordx2 v[42:43], v10, s[24:27], s38 offen offset:32 sc1
  v_perm_b32 v56, v98, v96, s40
  v_perm_b32 v57, v102, v100, s40
  v_perm_b32 v58, v106, v104, s40
  v_perm_b32 v59, v110, v108, s40
  v_perm_b32 v60, v98, v96, s41
  v_perm_b32 v61, v102, v100, s41
  v_perm_b32 v62, v106, v104, s41
  v_perm_b32 v63, v110, v108, s41
  v_perm_b32 v64, v99, v97, s40
  v_perm_b32 v65, v103, v101, s40
  v_perm_b32 v66, v107, v105, s40
  v_perm_b32 v67, v111, v109, s40
  v_perm_b32 v68, v99, v97, s41
  v_perm_b32 v69, v103, v101, s41
  v_perm_b32 v70, v107, v105, s41
  v_perm_b32 v71, v111, v109, s41
  s_waitcnt vmcnt(0)
  v_max_f32 v44, v40, v42
  v_sub_f32 v40, v40, v44
  v_sub_f32 v42, v42, v44
  v_mul_f32 v40, s42, v40
  v_mul_f32 v42, s42, v42
  v_exp_f32 v40, v40
  v_exp_f32 v42, v42
  s_nop 0
  v_mul_f32 v45, v40, v41
  v_fmac_f32 v45, v42, v43
  v_rcp_f32 v45, v45
  s_nop 0
  v_mul_f32 v40, v40, v45
  v_mul_f32 v42, v42, v45
  v_mul_f32 v32, v32, v40
  v_fmac_f32 v32, v36, v42
  v_mul_f32 v33, v33, v40
  v_fmac_f32 v33, v37, v42
  v_mul_f32 v34, v34, v40
  v_fmac_f32 v34, v38, v42
  v_mul_f32 v35, v35, v40
  v_fmac_f32 v35, v39, v42
  v_cvt_pk_bf16_f32 v32, v32, v33
  v_cvt_pk_bf16_f32 v33, v34, v35
  v_lshlrev_b32 v11, 9, v3
  v_lshl_add_u32 v11, v89, 3, v11
  ds_write_b64 v11, v[32:33] offset:17408
  s_waitcnt lgkmcnt(0)
  s_barrier
  v_lshlrev_b32 v11, 9, v83
  v_lshl_add_u32 v11, v3, 6, v11
  v_lshl_add_u32 v11, v84, 4, v11
  ds_read_b128 v[48:51], v11 offset:17408
  s_waitcnt lgkmcnt(0)
  s_nop 1
  v_mfma_f32_16x16x32_bf16 v[112:115], v[48:51], v[56:59], 0
  v_mfma_f32_16x16x32_bf16 v[116:119], v[48:51], v[60:63], 0
  v_mfma_f32_16x16x32_bf16 v[120:123], v[48:51], v[64:67], 0
  v_mfma_f32_16x16x32_bf16 v[124:127], v[48:51], v[68:71], 0
  v_lshlrev_b32 v8, 10, v84
  v_lshl_add_u32 v8, v83, 4, v8
  v_lshl_add_u32 v8, v3, 11, v8
  v_cmp_gt_u32 vcc, 32, v89
  s_nop 7
  s_nop 3
  s_and_saveexec_b64 s[36:37], vcc
  ds_write_b32 v8, v112 offset:25600
  ds_write_b32 v8, v113 offset:25856
  ds_write_b32 v8, v114 offset:26112
  ds_write_b32 v8, v115 offset:26368
  ds_write_b32 v8, v116 offset:25604
  ds_write_b32 v8, v117 offset:25860
  ds_write_b32 v8, v118 offset:26116
  ds_write_b32 v8, v119 offset:26372
  ds_write_b32 v8, v120 offset:25608
  ds_write_b32 v8, v121 offset:25864
  ds_write_b32 v8, v122 offset:26120
  ds_write_b32 v8, v123 offset:26376
  ds_write_b32 v8, v124 offset:25612
  ds_write_b32 v8, v125 offset:25868
  ds_write_b32 v8, v126 offset:26124
  ds_write_b32 v8, v127 offset:26380
  s_mov_b64 exec, s[36:37]
  s_waitcnt lgkmcnt(0)
  s_barrier
  v_lshlrev_b32 v9, 2, v0
  ds_read_b32 v16, v9 offset:25600
  ds_read_b32 v17, v9 offset:27648
  ds_read_b32 v18, v9 offset:29696
  ds_read_b32 v19, v9 offset:31744
  ds_read_b32 v20, v9 offset:33792
  ds_read_b32 v21, v9 offset:35840
  ds_read_b32 v22, v9 offset:37888
  ds_read_b32 v23, v9 offset:39936
  s_waitcnt lgkmcnt(0)
  v_add_f32 v16, v16, v17
  v_add_f32 v18, v18, v19
  v_add_f32 v20, v20, v21
  v_add_f32 v22, v22, v23
  v_add_f32 v16, v16, v18
  v_add_f32 v20, v20, v22
  v_add_f32 v16, v16, v20
  s_lshl_b32 s33, s28, 3
  s_add_u32 s33, s33, s70
  s_lshl_b32 s34, s33, 15
  s_add_u32 s34, s34, 0x100000
  s_lshl_b32 s35, s29, 1
  s_add_u32 s35, s35, s69
  s_lshl_b32 s35, s35, 11
  s_add_u32 s35, s35, s34
  buffer_store_dword v16, v9, s[24:27], s35 offen sc1
  s_waitcnt vmcnt(0)
  s_barrier
  s_cmp_lg_u32 s30, 0
  s_cbranch_scc1 L_o_wait
  s_lshl_b32 s31, s33, 8
  s_add_u32 s31, s31, 0x1c0000
  v_mov_b32 v87, 1
  s_mov_b64 s[36:37], exec
  s_mov_b64 exec, 1
  buffer_atomic_add v87, v90, s[24:27], s31 offen sc0 sc1
  s_waitcnt vmcnt(0)
  v_mov_b32 v88, 41984
  ds_write_b32 v88, v87
  s_waitcnt lgkmcnt(0)
  s_mov_b64 exec, s[36:37]
L_o_wait:
  s_barrier
  v_mov_b32 v88, 41984
  ds_read_b32 v87, v88
  s_waitcnt lgkmcnt(0)
  v_readfirstlane_b32 s39, v87
  s_cmp_lg_u32 s39, 15
  s_cbranch_scc1 L_fin
  s_add_u32 s35, s34, 0
  buffer_load_dword v16, v9, s[24:27], s35 offen sc1
  s_add_u32 s35, s34, 2048
  buffer_load_dword v17, v9, s[24:27], s35 offen sc1
  s_add_u32 s35, s34, 4096
  buffer_load_dword v18, v9, s[24:27], s35 offen sc1
  s_add_u32 s35, s34, 6144
  buffer_load_dword v19, v9, s[24:27], s35 offen sc1
  s_add_u32 s35, s34, 8192
  buffer_load_dword v20, v9, s[24:27], s35 offen sc1
  s_add_u32 s35, s34, 10240
  buffer_load_dword v21, v9, s[24:27], s35 offen sc1
  s_add_u32 s35, s34, 12288
  buffer_load_dword v22, v9, s[24:27], s35 offen sc1
  s_add_u32 s35, s34, 14336
  buffer_load_dword v23, v9, s[24:27], s35 offen sc1
  s_add_u32 s35, s34, 16384
  buffer_load_dword v24, v9, s[24:27], s35 offen sc1
  s_add_u32 s35, s34, 18432
  buffer_load_dword v25, v9, s[24:27], s35 offen sc1
  s_add_u32 s35, s34, 20480
  buffer_load_dword v26, v9, s[24:27], s35 offen sc1
  s_add_u32 s35, s34, 22528
  buffer_load_dword v27, v9, s[24:27], s35 offen sc1
  s_add_u32 s35, s34, 24576
  buffer_load_dword v28, v9, s[24:27], s35 offen sc1
  s_add_u32 s35, s34, 26624
  buffer_load_dword v29, v9, s[24:27], s35 offen sc1
  s_add_u32 s35, s34, 28672
  buffer_load_dword v30, v9, s[24:27], s35 offen sc1
  s_add_u32 s35, s34, 30720
  buffer_load_dword v31, v9, s[24:27], s35 offen sc1
  v_lshlrev_b32 v10, 11, v3
  v_lshl_add_u32 v10, v89, 1, v10
  s_lshl_b32 s35, s33, 7
  s_waitcnt vmcnt(0)
  v_add_f32 v16, v16, v17
  v_add_f32 v18, v18, v19
  v_add_f32 v20, v20, v21
  v_add_f32 v22, v22, v23
  v_add_f32 v24, v24, v25
  v_add_f32 v26, v26, v27
  v_add_f32 v28, v28, v29
  v_add_f32 v30, v30, v31
  v_add_f32 v16, v16, v18
  v_add_f32 v20, v20, v22
  v_add_f32 v24, v24, v26
  v_add_f32 v28, v28, v30
  v_add_f32 v16, v16, v20
  v_add_f32 v24, v24, v28
  v_add_f32 v16, v16, v24
  v_cvt_pk_bf16_f32 v16, v16, v16
  buffer_store_short v16, v10, s[60:63], s35 offen
  s_waitcnt vmcnt(0)
L_fin:
L_end:
  s_endpgm
.section .rodata,"a"
.p2align 6
.amdhsa_kernel concat_heads__gqa_block_cached__gqa_block_cached__decode_kernel
  .amdhsa_next_free_vgpr 224
  .amdhsa_next_free_sgpr 96
  .amdhsa_accum_offset 224
  .amdhsa_group_segment_fixed_size 0
  .amdhsa_kernarg_size 104
  .amdhsa_user_sgpr_count 2
  .amdhsa_user_sgpr_kernarg_segment_ptr 1
  .amdhsa_system_sgpr_workgroup_id_x 1
.end_amdhsa_kernel
```
